```python
import torch

def _softmax(x, axis=-1):
    return torch.softmax(x, dim=axis)

def _gelu(x):
    return torch.nn.functional.gelu(x, approximate='tanh')

def _silu(x):
    return torch.nn.functional.silu(x)

def _sigmoid(x):
    return torch.sigmoid(x)

def _layernorm(x, axis=-1, eps=1e-05):
    m = x.mean(dim=axis, keepdim=True)
    v = x.var(dim=axis, keepdim=True, unbiased=False)
    return (x - m) / torch.sqrt(v + eps)

def _scatter_add(tgt, idx, src, axis=0):
    return tgt.clone().index_add_(axis, idx, src)

def _segment_sum(src, seg, n):
    out = torch.zeros((n,) + src.shape[1:], dtype=src.dtype)
    return out.index_add_(0, seg, src)

def _pad(x, pw):
    flat = tuple((v for pair in reversed(pw) for v in pair))
    return torch.nn.functional.pad(x, flat)
kernel_name = 'standalone__neighborhood_dinat__vision'

def setup_inputs():

    _w = lambda a: (lambda t: t.to(torch.bfloat16) if t.is_floating_point() else t)(torch.as_tensor(a))
    ks, dil, nh = (7, 2, 4)
    H = W = max(ks * dil, 224 // dil * dil)
    C = max(nh, 96 // nh * nh)
    return {'x': _w((lambda *s: torch.randn(*s, dtype=torch.bfloat16) * 0.4)(1, H, W, C)), 'wqkv': _w((lambda *s: torch.randn(*s, dtype=torch.bfloat16) * 0.4)(C, 3 * C)), 'wo': _w((lambda *s: torch.randn(*s, dtype=torch.bfloat16) * 0.4)(C, C)), 'rpb': _w((lambda *s: torch.randn(*s, dtype=torch.bfloat16) * 0.4)(nh, 2 * ks - 1, 2 * ks - 1))}

def reference(x, wqkv, wo, rpb):
    B, H, W, C = x.shape
    ks, dil, nh = (7, 2, 4)
    hd = C // nh
    scale = hd ** (-0.5)
    qkv = (x @ wqkv).reshape(B, H, W, 3, nh, hd)
    q = qkv[:, :, :, 0].clone()
    k = qkv[:, :, :, 1].clone()
    v = qkv[:, :, :, 2].clone()
    ih = torch.arange(H)
    iw = torch.arange(W)
    m = torch.arange(ks)
    sh = torch.clip(ih // dil - ks // 2, 0, H // dil - ks)
    sw = torch.clip(iw // dil - ks // 2, 0, W // dil - ks)
    kh = (sh[:, None] + m[None, :]) * dil + (ih % dil)[:, None]
    kw = (sw[:, None] + m[None, :]) * dil + (iw % dil)[:, None]
    rh = sh[:, None] + m[None, :] - (ih // dil)[:, None] + (ks - 1)
    rw = sw[:, None] + m[None, :] - (iw // dil)[:, None] + (ks - 1)
    ih4 = kh[:, :, None, None].clone()
    iw4 = kw[None, None, :, :].clone()
    kg = (lambda x, *d: x.permute(*d))(k[:, ih4, iw4, :, :], 0, 1, 3, 5, 2, 4, 6).reshape(B, H, W, nh, ks * ks, hd)
    vg = (lambda x, *d: x.permute(*d))(v[:, ih4, iw4, :, :], 0, 1, 3, 5, 2, 4, 6).reshape(B, H, W, nh, ks * ks, hd)
    bg = (lambda x, *d: x.permute(*d))(rpb[:, rh[:, :, None, None], rw[None, None, :, :]], 1, 3, 0, 2, 4).reshape(1, H, W, nh, ks * ks)
    logits = torch.einsum('bhwnd,bhwnkd->bhwnk', q, kg) * scale + bg
    attn = _softmax(logits, axis=-1)
    out = torch.einsum('bhwnk,bhwnkd->bhwnd', attn, vg).reshape(B, H, W, C)
    return out @ wo
```

```asm
; @launch grid=(256,1,1) block=(768,1,1) lds=163840
.amdgcn_target "amdgcn-amd-amdhsa--gfx950"
.text
.globl standalone__neighborhood_dinat__vision_kernel
.p2align 12

.p2align 8
.type standalone__neighborhood_dinat__vision_kernel,@function
standalone__neighborhood_dinat__vision_kernel:
    s_cmp_ge_u32 s2, 256
    s_cbranch_scc1 L_end
    s_load_dwordx2 s[16:17], s[0:1], 0
    s_load_dwordx2 s[20:21], s[0:1], 8
    s_load_dwordx2 s[28:29], s[0:1], 24
    s_getpc_b64 s[4:5]
    v_cmpx_gt_u32 vcc, 55, v0
    s_cbranch_execz L_nopf
    s_and_b32 s61, s2, 24
    s_mul_i32 s61, s61, 880
    v_lshl_add_u32 v1, v0, 7, s61
    global_load_dword v135, v1, s[4:5]
L_nopf:
    s_mov_b64 exec, -1
    v_readfirstlane_b32 s3, v0
    s_mov_b32 s36, 0
    v_and_b32 v0, 63, v0
    s_lshr_b32 s3, s3, 6
L_restart:
    s_sub_u32 s6, 4, s2
    s_and_b32 s6, s6, 7
    s_and_b32 s52, s3, 3
    s_lshr_b32 s53, s3, 3
    s_cmp_lt_u32 s3, 4
    s_cbranch_scc1 L_pin
    s_setprio 2
    v_mul_u32_u24 v120, 43, v0
    s_lshl1_add_u32 s65, s52, s53
    s_mul_i32 s64, s6, 14
    v_lshrrev_b32 v120, 9, v120
    s_mul_i32 s54, s65, 1920
    s_mul_i32 s65, s65, 10
    v_mul_u32_u24 v121, 192, v120
    s_add_u32 s64, s64, s52
    s_sub_u32 s62, 19, s52
    v_add_lshl_u32 v120, v120, s65, 2
    s_cmp_eq_u32 s6, 0
    s_cselect_b32 s64, s62, s64
    v_lshl_add_u32 v121, v0, 4, v121
    s_cselect_b32 s41, -4, 4
    s_lshr_b32 s61, s2, 4
    v_add_u32 v122, 20, v120
    s_lshl4_add_u32 s64, s64, s61
    s_mul_i32 s62, s53, 10
    v_bitop3_b32 v157, v121, v120, 32 bitop3:0x78
    s_mul_i32 s64, s64, 14
    s_bfe_u32 s63, s2, 0x10003
    v_bitop3_b32 v158, v121, v122, 32 bitop3:0x78
    s_add_u32 s64, s64, s62
    s_lshl1_add_u32 s64, s64, s63
    s_add_u32 s54, s54, 4608
    s_mul_i32 s40, s64, 192
    s_mov_b32 s18, 9633792
    s_mov_b32 s19, 0x20000
    s_sub_u32 s40, s40, 259200
    s_mul_i32 s41, s41, 86016
    s_waitcnt lgkmcnt(0)
    s_cmp_lg_u32 s3, 7
    s_cbranch_scc1 L_nwa
    s_lshr_b32 s61, s2, 3
    s_mov_b32 s22, 55296
    s_mul_i32 s61, s61, 1792
    s_mov_b32 s23, 0x20000
    s_bfm_b64 exec, 14, 0
    v_lshl_add_u32 v1, v0, 7, s61
    buffer_load_dword v160, v1, s[20:23], 0 offen
    s_mov_b32 exec_lo, -1
L_nwa:
    s_mov_b32 exec_hi, 0x0fffffff
    s_add_u32 m0, s54, 0
    s_nop 0
    buffer_load_dwordx4 v157, s[16:19], s40 offen offset:0 nt lds
    s_add_u32 m0, s54, -960
    s_nop 0
    buffer_load_dwordx4 v158, s[16:19], s40 offen offset:1920 nt lds
    s_mov_b32 exec_hi, -1
    s_cmp_lg_u32 s52, 0
    s_cbranch_scc1 L_com
    s_mul_i32 s61, s41, 1
    s_add_u32 s61, s61, s40
    s_mov_b32 exec_hi, 0x0fffffff
    s_add_u32 m0, s54, 15360
    s_nop 0
    buffer_load_dwordx4 v157, s[16:19], s61 offen offset:0 nt lds
    s_add_u32 m0, s54, 14400
    s_nop 0
    buffer_load_dwordx4 v158, s[16:19], s61 offen offset:1920 nt lds
    s_mov_b32 exec_hi, -1
    s_branch L_com
L_pin:
    s_setprio 3
    s_cmp_eq_u32 s6, 0
    v_lshrrev_b32 v120, 4, v0
    s_cselect_b32 s37, 3, 0
    v_and_b32 v121, 15, v0
    s_cselect_b32 s62, 26, 0
    v_xor_b32 v122, s37, v120
    s_mul_i32 s63, s3, 338
    v_mul_u32_u24 v122, 26, v122
    s_add_u32 s62, s62, s63
    v_lshl_add_u32 v122, v121, 1, v122
    s_movk_i32 s30, 1352
    v_mov_b32 v132, 0xff80
    s_mov_b32 s31, 0x20000
    v_mov_b32 v133, 0xff80
    s_and_b32 s59, s3, 1
    v_mov_b32 v134, 0xff80
    s_lshr_b32 s60, s3, 1
    v_lshlrev_b32 v140, 4, v0
    s_mul_i32 s59, s59, 9216
    v_bitop3_b32 v142, v140, v0, 32 bitop3:0x78
    s_lshl_b32 s61, s60, 11
    v_xor_b32 v141, 32, v140
    s_mov_b32 s22, 55296
    s_add_u32 s59, s59, s61
    s_mov_b32 s23, 0x20000
    s_add_u32 m0, s59, 66048
    s_mov_b32 exec_lo, 0x1fff1fff
    s_mov_b32 exec_hi, 0x1fff1fff
    s_waitcnt lgkmcnt(0)
    buffer_load_ushort v132, v122, s[28:31], s62 offen offset:0
    buffer_load_ushort v133, v122, s[28:31], s62 offen offset:104
    buffer_load_ushort v134, v122, s[28:31], s62 offen offset:208
    s_mov_b64 exec, -1
    s_setprio 1
L_com:
    v_and_b32 v121, 15, v0
    s_mul_i32 s7, s52, 96
    v_lshrrev_b32 v120, 4, v0
    s_mul_i32 s63, s53, 12800
    v_lshrrev_b32 v122, 2, v121
    s_add_u32 s7, s7, 99840
    v_mul_u32_u24 v124, 12, v121
    s_add_u32 s62, s7, s63
    v_bitop3_b32 v5, v120, v122, 2 bitop3:0x78
    s_mul_i32 s63, s53, 6144
    v_mul_u32_u24 v7, 400, v121
    s_add_u32 s63, s63, 4608
    v_add_lshl_u32 v5, v5, v124, 4
    s_mul_i32 s64, s52, 3
    v_add_u32 v7, s62, v7
    v_add_u32 v5, s63, v5
    v_lshl_add_u32 v6, v120, 4, v7
    v_lshl_add_u32 v7, v120, 3, v7
    v_lshl_add_u32 v122, v120, 3, v122
    v_and_b32 v125, 3, v0
    v_mul_u32_u24 v122, 576, v122
    v_lshlrev_b32 v123, 1, v120
    v_cmp_eq_u32 vcc, 3, v125
    v_add_u32 v122, 66048, v122
    v_and_b32 v126, 2, v0
    v_cndmask_b32 v127, v125, 13, vcc
    v_and_b32 v129, 1, v0
    v_lshl_add_u32 v128, v126, 2, v122
    v_lshl_add_u32 v129, v129, 3, v122
    v_add3_u32 v163, v126, s64, 24
    v_add3_u32 v161, v127, s64, 12
    v_bitop3_b32 v163, v163, v123, 2 bitop3:0x78
    v_bitop3_b32 v161, v161, v123, 2 bitop3:0x78
    v_lshl_add_u32 v163, v163, 4, v129
    v_lshl_add_u32 v161, v161, 4, v128
    v_xor_b32 v162, 8, v161
    s_cmp_lt_u32 s3, 4
    s_cbranch_scc1 L_prod
    s_setprio 0
    v_and_b32 v126, 7, v0
    s_bfe_u32 s63, s2, 0x30004
    v_bfe_u32 v127, v0, 3, 1
    s_lshl1_add_u32 s63, s63, s53
    v_min_u32 v126, 6, v126
    s_mul_i32 s63, s63, 7
    v_mul_i32_i24 v127, -68, v127
    s_sub_u32 s63, s63, 3
    v_lshlrev_b32 v129, 1, v120
    s_movk_i32 s64, 105
    v_add_u32 v128, s63, v126
    s_lshl_b32 s62, s52, 10
    v_med3_i32 v128, v128, 0, s64
    s_add_u32 s62, s62, 592
    v_subrev_u32 v128, s63, v128
    s_sub_u32 s38, s6, 1
    v_add_u32 v127, s62, v127
    s_cmp_ge_u32 s38, 6
    v_cmp_ge_u32 s[46:47], v129, v128
    v_or_b32 v129, 1, v129
    s_cselect_b32 s38, 1, 0
    v_mad_i32_i24 v126, v126, -4, v127
    v_cmp_ge_u32 s[48:49], v129, v128
    v_lshl_add_u32 v126, v120, 3, v126
    v_cmp_eq_u32 vcc, 3, v120
    v_add_u32 v128, 28, v126
    v_add_u32 v127, 40, v127
    v_cndmask_b32 v1, v128, v126, s[46:47]
    v_cndmask_b32 v2, v128, v126, s[48:49]
    s_not_b64 s[50:51], s[46:47]
    s_not_b64 s[8:9], s[48:49]
    v_cndmask_b32 v2, v2, v127, vcc
    v_and_b32 v126, 1, v121
    s_mul_i32 s62, s53, 2800
    v_lshrrev_b32 v127, 1, v121
    s_add_u32 s62, s62, s7
    s_movk_i32 s65, 400
    v_min_u32 v129, 5, v127
    s_mul_i32 s63, s3, 768
    v_mad_u32_u24 v148, v126, 20, v127
    s_add_u32 s63, s63, 78336
    v_mad_u32_u24 v149, v126, 20, v129
    s_mov_b32 s44, -1
    v_lshl_add_u32 v126, v120, 4, s62
    s_mov_b32 s45, 0xffff
    v_mad_u32_u24 v148, v148, s65, v126
    v_and_b32 v127, 60, v0
    v_mad_u32_u24 v149, v149, s65, v126
    ds_bpermute_b32 v150, v127, v148
    v_sub_u32 v128, 1, v125
    v_cmp_gt_u32 vcc, 2, v125
    ds_bpermute_b32 v152, v127, v149
    v_lshl_add_u32 v154, v0, 4, s63
    v_lshl_add_u32 v126, v121, 4, s63
    v_cndmask_b32 v128, v128, v125, vcc
    v_and_b32 v129, 1, v120
    v_lshrrev_b32 v130, 1, v120
    v_lshl_add_u32 v126, v129, 3, v126
    v_mov_b32 v151, 100144
    v_lshl_add_u32 v155, v130, 8, v126
    v_lshl_add_u32 v156, v130, 2, v126
    v_mov_b32 v153, 97344
    v_mov_b64 v[144:145], 0
    v_mov_b64 v[146:147], 0
    v_mov_b64 v[164:165], 0
    v_mov_b64 v[166:167], 0
    v_mov_b32 v159, 0
    v_mov_b64 v[88:89], 0
    v_mov_b64 v[90:91], 0
    v_mov_b64 v[92:93], 0
    v_mov_b64 v[94:95], 0
    v_mov_b64 v[96:97], 0
    v_mov_b64 v[98:99], 0
    v_mov_b64 v[100:101], 0
    v_mov_b64 v[102:103], 0
    s_waitcnt lgkmcnt(1)
    v_lshl_add_u32 v150, v128, 3, v150
    s_waitcnt lgkmcnt(0)
    v_lshl_add_u32 v152, v128, 3, v152
    v_cndmask_b32 v151, v151, v150, vcc
    v_cndmask_b32 v153, v153, v152, vcc
    s_waitcnt lgkmcnt(0)
    s_barrier
    ds_read2_b32 v[72:73], v1 offset0:85 offset1:102
    ds_read2_b32 v[74:75], v2 offset0:86 offset1:103
    ds_read2_b32 v[76:77], v1 offset0:119 offset1:136
    ds_read2_b32 v[78:79], v2 offset0:120 offset1:137
    ds_read2_b32 v[80:81], v1 offset0:153 offset1:170
    ds_read2_b32 v[82:83], v2 offset0:154 offset1:171
    ds_read2_b32 v[84:85], v1 offset0:187 offset1:204
    ds_read2_b32 v[86:87], v2 offset0:188 offset1:205
    s_setprio 2
    s_cmp_eq_u32 s53, 0
    s_cbranch_scc1 L_hp0
    s_setprio 0
L_hp0:
    s_waitcnt vmcnt(0) lgkmcnt(0)
    s_barrier
    ds_read_b128 v[20:23], v5 offset:0
    ds_read_b64_tr_b16 v[40:41], v161 offset:0
    ds_read_b64_tr_b16 v[42:43], v161 offset:2304
    ds_read_b64_tr_b16 v[44:45], v162 offset:0
    ds_read_b64_tr_b16 v[46:47], v162 offset:2304
    ds_read_b64_tr_b16 v[48:49], v163 offset:0
    ds_read_b64_tr_b16 v[50:51], v163 offset:2304
    ds_read_b128 v[24:27], v5 offset:3072
    s_waitcnt lgkmcnt(5)
    v_mfma_f32_16x16x32_bf16 v[8:11], v[40:43], v[20:23], 0
    ds_read_b128 v[140:143], v5 offset:64
    s_waitcnt lgkmcnt(4)
    v_mfma_f32_16x16x32_bf16 v[12:15], v[44:47], v[20:23], 0
    ds_read_b128 v[28:31], v5 offset:3136
    s_waitcnt lgkmcnt(3)
    v_mfma_f32_16x16x32_bf16 v[16:19], v[48:51], v[20:23], 0
    ds_read_b128 v[104:107], v5 offset:128
    s_waitcnt lgkmcnt(3)
    v_mfma_f32_16x16x32_bf16 v[108:111], v[40:43], v[24:27], 0
    ds_read_b128 v[32:35], v5 offset:3200
    v_mfma_f32_16x16x32_bf16 v[112:115], v[44:47], v[24:27], 0
    v_mfma_f32_16x16x32_bf16 v[116:119], v[48:51], v[24:27], 0
    s_cmp_eq_u32 s52, 0
    s_cbranch_scc1 L_x1l
    s_mul_i32 s61, s41, 1
    s_add_u32 s61, s61, s40
    s_mov_b32 exec_hi, 0x0fffffff
    s_add_u32 m0, s54, 15360
    s_nop 0
    buffer_load_dwordx4 v157, s[16:19], s61 offen offset:0 nt lds
    s_add_u32 m0, s54, 14400
    s_nop 0
    buffer_load_dwordx4 v158, s[16:19], s61 offen offset:1920 nt lds
    s_mov_b32 exec_hi, -1
L_x1l:
    s_waitcnt lgkmcnt(0)
    s_barrier
    ds_read_b64_tr_b16 v[52:53], v161 offset:27648
    ds_read_b64_tr_b16 v[54:55], v161 offset:29952
    ds_read_b64_tr_b16 v[56:57], v162 offset:27648
    ds_read_b64_tr_b16 v[58:59], v162 offset:29952
    ds_read_b64_tr_b16 v[60:61], v163 offset:27648
    ds_read_b64_tr_b16 v[62:63], v163 offset:29952
    ds_read_b64_tr_b16 v[64:65], v161 offset:46080
    ds_read_b64_tr_b16 v[66:67], v161 offset:48384
    s_waitcnt lgkmcnt(6)
    v_mfma_f32_16x16x32_bf16 v[8:11], v[52:55], v[140:143], v[8:11]
    ds_read_b64_tr_b16 v[68:69], v162 offset:46080
    s_waitcnt lgkmcnt(5)
    v_mfma_f32_16x16x32_bf16 v[12:15], v[56:59], v[140:143], v[12:15]
    ds_read_b64_tr_b16 v[70:71], v162 offset:48384
    s_waitcnt lgkmcnt(4)
    v_mfma_f32_16x16x32_bf16 v[16:19], v[60:63], v[140:143], v[16:19]
    ds_read_b64_tr_b16 v[136:137], v163 offset:46080
    v_mfma_f32_16x16x32_bf16 v[108:111], v[52:55], v[28:31], v[108:111]
    ds_read_b64_tr_b16 v[138:139], v163 offset:48384
    v_mfma_f32_16x16x32_bf16 v[112:115], v[56:59], v[28:31], v[112:115]
    v_mfma_f32_16x16x32_bf16 v[116:119], v[60:63], v[28:31], v[116:119]
    s_waitcnt lgkmcnt(4)
    v_mfma_f32_16x16x32_bf16 v[8:11], v[64:67], v[104:107], v[8:11]
    s_waitcnt lgkmcnt(2)
    v_mfma_f32_16x16x32_bf16 v[12:15], v[68:71], v[104:107], v[12:15]
    s_waitcnt lgkmcnt(0)
    v_mfma_f32_16x16x32_bf16 v[16:19], v[136:139], v[104:107], v[16:19]
    v_mfma_f32_16x16x32_bf16 v[108:111], v[64:67], v[32:35], v[108:111]
    v_mfma_f32_16x16x32_bf16 v[112:115], v[68:71], v[32:35], v[112:115]
    v_mfma_f32_16x16x32_bf16 v[116:119], v[136:139], v[32:35], v[116:119]
    s_mul_i32 s61, s41, 2
    s_add_u32 s61, s61, s40
    s_mov_b32 exec_hi, 0x0fffffff
    s_add_u32 m0, s54, 30720
    s_nop 0
    buffer_load_dwordx4 v157, s[16:19], s61 offen offset:0 nt lds
    s_add_u32 m0, s54, 29760
    s_nop 0
    buffer_load_dwordx4 v158, s[16:19], s61 offen offset:1920 nt lds
    s_mov_b32 exec_hi, -1
    v_cvt_pk_bf16_f32 v8, v8, v9
    v_cvt_pk_bf16_f32 v9, v10, v11
    v_cvt_pk_bf16_f32 v10, v12, v13
    v_cvt_pk_bf16_f32 v11, v14, v15
    ds_write_b128 v6, v[8:11] offset:32000
    v_cvt_pk_bf16_f32 v16, v16, v17
    v_cvt_pk_bf16_f32 v17, v18, v19
    ds_write_b64 v7, v[16:17] offset:32064
    v_cvt_pk_bf16_f32 v108, v108, v109
    v_cvt_pk_bf16_f32 v109, v110, v111
    v_cvt_pk_bf16_f32 v110, v112, v113
    v_cvt_pk_bf16_f32 v111, v114, v115
    ds_write_b128 v6, v[108:111] offset:38400
    v_cvt_pk_bf16_f32 v116, v116, v117
    v_cvt_pk_bf16_f32 v117, v118, v119
    ds_write_b64 v7, v[116:117] offset:38464
    s_setprio 0
    s_cmp_eq_u32 s53, 0
    s_cbranch_scc1 L_hp1
    s_setprio 0
L_hp1:
    s_waitcnt vmcnt(2) lgkmcnt(0)
    s_barrier
    ds_read_b128 v[20:23], v5 offset:15360
    ds_read_b128 v[140:143], v5 offset:15424
    ds_read_b128 v[104:107], v5 offset:15488
    s_mov_b64 exec, s[44:45]
    ds_read_b128 v[144:147], v154 offset:6144
    s_mov_b64 exec, -1
    ds_read_b128 v[24:27], v148 offset:32000
    ds_read_b128 v[28:31], v149 offset:34800
    ds_read_b128 v[32:35], v148 offset:48000
    ds_read_b128 v[36:39], v149 offset:50800
    s_waitcnt lgkmcnt(7)
    v_mfma_f32_16x16x32_bf16 v[8:11], v[40:43], v[20:23], 0
    v_mfma_f32_16x16x32_bf16 v[12:15], v[44:47], v[20:23], 0
    v_mfma_f32_16x16x32_bf16 v[16:19], v[48:51], v[20:23], 0
    s_waitcnt lgkmcnt(6)
    v_mfma_f32_16x16x32_bf16 v[8:11], v[52:55], v[140:143], v[8:11]
    v_mfma_f32_16x16x32_bf16 v[12:15], v[56:59], v[140:143], v[12:15]
    v_mfma_f32_16x16x32_bf16 v[16:19], v[60:63], v[140:143], v[16:19]
    ds_read_b128 v[20:23], v5 offset:18432
    s_waitcnt lgkmcnt(6)
    v_mfma_f32_16x16x32_bf16 v[8:11], v[64:67], v[104:107], v[8:11]
    v_mfma_f32_16x16x32_bf16 v[12:15], v[68:71], v[104:107], v[12:15]
    v_mfma_f32_16x16x32_bf16 v[16:19], v[136:139], v[104:107], v[16:19]
    ds_read_b128 v[140:143], v5 offset:18496
    s_waitcnt lgkmcnt(5)
    v_mfma_f32_16x16x32_bf16 v[120:123], v[24:27], v[144:147], v[72:75]
    ds_read_b128 v[104:107], v5 offset:18560
    s_waitcnt lgkmcnt(5)
    v_mfma_f32_16x16x32_bf16 v[124:127], v[28:31], v[144:147], v[72:75]
    s_waitcnt lgkmcnt(4)
    v_mfma_f32_16x16x32_bf16 v[128:131], v[32:35], v[144:147], v[76:79]
    v_cvt_pk_bf16_f32 v8, v8, v9
    v_cvt_pk_bf16_f32 v9, v10, v11
    s_waitcnt lgkmcnt(3)
    v_mfma_f32_16x16x32_bf16 v[132:135], v[36:39], v[144:147], v[76:79]
    v_cvt_pk_bf16_f32 v10, v12, v13
    v_cvt_pk_bf16_f32 v11, v14, v15
    s_waitcnt lgkmcnt(2)
    v_mfma_f32_16x16x32_bf16 v[108:111], v[40:43], v[20:23], 0
    ds_write_b128 v6, v[8:11] offset:0
    v_cvt_pk_bf16_f32 v16, v16, v17
    v_mfma_f32_16x16x32_bf16 v[112:115], v[44:47], v[20:23], 0
    v_cvt_pk_bf16_f32 v17, v18, v19
    ds_write_b64 v7, v[16:17] offset:64
    v_mfma_f32_16x16x32_bf16 v[116:119], v[48:51], v[20:23], 0
    s_mov_b64 exec, s[50:51]
    v_mov_b64 v[120:121], v[124:125]
    s_mov_b64 exec, s[8:9]
    v_mov_b64 v[122:123], v[126:127]
    s_mov_b64 exec, -1
    s_waitcnt lgkmcnt(3)
    v_mfma_f32_16x16x32_bf16 v[108:111], v[52:55], v[140:143], v[108:111]
    v_exp_f32 v120, v120
    v_exp_f32 v121, v121
    v_mfma_f32_16x16x32_bf16 v[112:115], v[56:59], v[140:143], v[112:115]
    v_exp_f32 v122, v122
    v_exp_f32 v123, v123
    v_mfma_f32_16x16x32_bf16 v[116:119], v[60:63], v[140:143], v[116:119]
    s_mov_b64 exec, s[46:47]
    v_cvt_pk_bf16_f32 v96, v120, v121
    s_mov_b64 exec, s[50:51]
    v_cvt_pk_bf16_f32 v98, v120, v121
    s_waitcnt lgkmcnt(2)
    v_mfma_f32_16x16x32_bf16 v[108:111], v[64:67], v[104:107], v[108:111]
    v_mov_b64 v[128:129], v[132:133]
    s_mov_b64 exec, s[48:49]
    v_cvt_pk_bf16_f32 v97, v122, v123
    v_mfma_f32_16x16x32_bf16 v[112:115], v[68:71], v[104:107], v[112:115]
    s_mov_b64 exec, s[8:9]
    v_cvt_pk_bf16_f32 v99, v122, v123
    v_mov_b64 v[130:131], v[134:135]
    s_mov_b64 exec, -1
    v_mfma_f32_16x16x32_bf16 v[116:119], v[136:139], v[104:107], v[116:119]
    ds_read_b64_tr_b16 v[56:57], v150 offset:32064
    ds_read_b64_tr_b16 v[58:59], v152 offset:34864
    ds_read_b64_tr_b16 v[60:61], v151 offset:32080
    ds_read_b64_tr_b16 v[62:63], v153 offset:34880
    ds_read_b64_tr_b16 v[64:65], v150 offset:48064
    ds_read_b64_tr_b16 v[66:67], v152 offset:50864
    ds_read_b64_tr_b16 v[68:69], v151 offset:48080
    ds_read_b64_tr_b16 v[70:71], v153 offset:50880
    v_cvt_pk_bf16_f32 v108, v108, v109
    v_cvt_pk_bf16_f32 v109, v110, v111
    v_cvt_pk_bf16_f32 v110, v112, v113
    v_cvt_pk_bf16_f32 v111, v114, v115
    ds_write_b128 v6, v[108:111] offset:6400
    v_cvt_pk_bf16_f32 v116, v116, v117
    v_cvt_pk_bf16_f32 v117, v118, v119
    ds_write_b64 v7, v[116:117] offset:6464
    s_mul_i32 s61, s41, 3
    s_add_u32 s61, s61, s40
    s_mov_b32 exec_hi, 0x0fffffff
    s_add_u32 m0, s54, 46080
    s_nop 0
    buffer_load_dwordx4 v157, s[16:19], s61 offen offset:0 nt lds
    s_add_u32 m0, s54, 45120
    s_nop 0
    buffer_load_dwordx4 v158, s[16:19], s61 offen offset:1920 nt lds
    s_mov_b32 exec_hi, -1
    s_setprio 0
    s_waitcnt vmcnt(2) lgkmcnt(0)
    s_barrier
    s_cmp_lg_u32 s36, 0
    s_cbranch_scc1 L_slow
    s_cmp_lg_u32 s53, 0
    s_cbranch_scc1 L_attg
    ds_read_b128 v[8:11], v148 offset:0
    ds_read_b128 v[12:15], v149 offset:2800
    ds_read_b128 v[16:19], v148 offset:16000
    ds_read_b128 v[20:23], v149 offset:18800
    s_setprio 2
    v_mfma_f32_16x16x32_bf16 v[136:139], v[56:59], v[96:99], 0
    v_mfma_f32_16x16x32_bf16 v[140:143], v[60:63], v[96:99], 0
    s_setprio 0
    v_exp_f32 v128, v128
    v_exp_f32 v129, v129
    s_mov_b64 exec, s[44:45]
    ds_read_b128 v[164:167], v154 offset:12288
    s_mov_b64 exec, -1
    v_exp_f32 v130, v130
    s_setprio 2
    s_waitcnt lgkmcnt(4)
    v_mfma_f32_16x16x32_bf16 v[104:107], v[8:11], v[144:147], v[80:83]
    s_setprio 0
    v_exp_f32 v131, v131
    s_setprio 2
    s_waitcnt lgkmcnt(3)
    v_mfma_f32_16x16x32_bf16 v[108:111], v[12:15], v[144:147], v[80:83]
    s_waitcnt lgkmcnt(2)
    v_mfma_f32_16x16x32_bf16 v[112:115], v[16:19], v[144:147], v[84:87]
    ds_read_b64_tr_b16 v[40:41], v150 offset:64
    s_waitcnt lgkmcnt(2)
    v_mfma_f32_16x16x32_bf16 v[116:119], v[20:23], v[144:147], v[84:87]
    ds_read_b64_tr_b16 v[42:43], v152 offset:2864
    ds_read_b64_tr_b16 v[44:45], v151 offset:80
    ds_read_b64_tr_b16 v[46:47], v153 offset:2880
    s_mov_b64 exec, s[46:47]
    s_setprio 0
    v_cvt_pk_bf16_f32 v100, v128, v129
    s_mov_b64 exec, s[50:51]
    v_cvt_pk_bf16_f32 v102, v128, v129
    v_mov_b64 v[104:105], v[108:109]
    s_mov_b64 exec, s[48:49]
    v_cvt_pk_bf16_f32 v101, v130, v131
    s_mov_b64 exec, s[8:9]
    v_cvt_pk_bf16_f32 v103, v130, v131
    v_mov_b64 v[106:107], v[110:111]
    s_mov_b64 exec, -1
    v_exp_f32 v104, v104
    s_setprio 2
    v_mfma_f32_16x16x32_bf16 v[136:139], v[64:67], v[100:103], v[136:139]
    s_setprio 0
    v_exp_f32 v105, v105
    s_setprio 2
    v_mfma_f32_16x16x32_bf16 v[140:143], v[68:71], v[100:103], v[140:143]
    s_setprio 0
    v_exp_f32 v106, v106
    v_exp_f32 v107, v107
    ds_read_b64_tr_b16 v[48:49], v150 offset:16064
    ds_read_b64_tr_b16 v[50:51], v152 offset:18864
    ds_read_b64_tr_b16 v[52:53], v151 offset:16080
    ds_read_b64_tr_b16 v[54:55], v153 offset:18880
    s_setprio 2
    s_waitcnt lgkmcnt(8)
    v_mfma_f32_16x16x32_bf16 v[128:131], v[32:35], v[164:167], v[72:75]
    s_mov_b64 exec, s[46:47]
    s_setprio 0
    v_cvt_pk_bf16_f32 v88, v104, v105
    s_setprio 2
    v_mfma_f32_16x16x32_bf16 v[132:135], v[36:39], v[164:167], v[72:75]
    s_mov_b64 exec, s[50:51]
    s_setprio 0
    v_cvt_pk_bf16_f32 v90, v104, v105
    v_mov_b64 v[112:113], v[116:117]
    s_mov_b64 exec, s[48:49]
    v_cvt_pk_bf16_f32 v89, v106, v107
    s_mov_b64 exec, s[8:9]
    v_cvt_pk_bf16_f32 v91, v106, v107
    v_mov_b64 v[114:115], v[118:119]
    s_mov_b64 exec, -1
    v_exp_f32 v112, v112
    s_setprio 2
    s_waitcnt lgkmcnt(6)
    v_mfma_f32_16x16x32_bf16 v[136:139], v[40:43], v[88:91], v[136:139]
    s_setprio 0
    v_exp_f32 v113, v113
    s_setprio 2
    s_waitcnt lgkmcnt(4)
    v_mfma_f32_16x16x32_bf16 v[140:143], v[44:47], v[88:91], v[140:143]
    s_setprio 0
    v_exp_f32 v114, v114
    s_setprio 2
    v_mfma_f32_16x16x32_bf16 v[104:107], v[8:11], v[164:167], v[76:79]
    s_setprio 0
    v_exp_f32 v115, v115
    s_setprio 2
    v_mfma_f32_16x16x32_bf16 v[108:111], v[12:15], v[164:167], v[76:79]
    s_mov_b64 exec, s[46:47]
    s_setprio 0
    v_cvt_pk_bf16_f32 v92, v112, v113
    s_mov_b64 exec, s[50:51]
    v_cvt_pk_bf16_f32 v94, v112, v113
    v_mov_b64 v[128:129], v[132:133]
    s_mov_b64 exec, s[48:49]
    v_cvt_pk_bf16_f32 v93, v114, v115
    s_mov_b64 exec, s[8:9]
    v_cvt_pk_bf16_f32 v95, v114, v115
    v_mov_b64 v[130:131], v[134:135]
    s_mov_b64 exec, -1
    v_exp_f32 v128, v128
    s_setprio 2
    s_waitcnt lgkmcnt(2)
    v_mfma_f32_16x16x32_bf16 v[136:139], v[48:51], v[92:95], v[136:139]
    s_setprio 0
    v_exp_f32 v129, v129
    s_setprio 2
    s_waitcnt lgkmcnt(0)
    v_mfma_f32_16x16x32_bf16 v[140:143], v[52:55], v[92:95], v[140:143]
    s_setprio 0
    v_exp_f32 v130, v130
    s_setprio 2
    v_mfma_f32_16x16x32_bf16 v[112:115], v[16:19], v[164:167], v[80:83]
    s_setprio 0
    v_exp_f32 v131, v131
    s_setprio 2
    v_mfma_f32_16x16x32_bf16 v[116:119], v[20:23], v[164:167], v[80:83]
    s_mov_b64 exec, s[46:47]
    s_setprio 0
    v_cvt_pk_bf16_f32 v100, v128, v129
    s_mov_b64 exec, s[50:51]
    v_cvt_pk_bf16_f32 v102, v128, v129
    v_mov_b64 v[104:105], v[108:109]
    s_mov_b64 exec, s[48:49]
    v_cvt_pk_bf16_f32 v101, v130, v131
    s_mov_b64 exec, s[8:9]
    v_cvt_pk_bf16_f32 v103, v130, v131
    v_mov_b64 v[106:107], v[110:111]
    s_mov_b64 exec, -1
    v_permlane32_swap_b32 v140, v142
    v_permlane32_swap_b32 v141, v143
    v_rcp_f32 v160, v142
    s_nop 0
    v_max3_f32 v159, v159, v142, v160
    v_mul_f32 v136, v136, v160
    v_mul_f32 v137, v137, v160
    v_mul_f32 v138, v138, v160
    v_mul_f32 v139, v139, v160
    v_cvt_pk_bf16_f32 v136, v136, v137
    v_cvt_pk_bf16_f32 v137, v138, v139
    v_mul_f32 v140, v140, v160
    v_mul_f32 v141, v141, v160
    ds_write_b64 v155, v[136:137] offset:12288
    v_cvt_pk_bf16_f32 v140, v140, v141
    ds_write_b32 v156, v140 offset:12800
    v_exp_f32 v104, v104
    s_setprio 2
    v_mfma_f32_16x16x32_bf16 v[136:139], v[64:67], v[100:103], 0
    s_setprio 0
    v_exp_f32 v105, v105
    s_setprio 2
    v_mfma_f32_16x16x32_bf16 v[140:143], v[68:71], v[100:103], 0
    s_setprio 0
    v_exp_f32 v106, v106
    v_exp_f32 v107, v107
    s_waitcnt vmcnt(0) lgkmcnt(0)
    s_barrier
    s_mul_i32 s61, s41, 4
    s_add_u32 s61, s61, s40
    v_add_u32 v157, s61, v157
    s_add_u32 s61, s61, 1920
    v_add_u32 v158, s61, v158
    s_mov_b32 exec_hi, 0x0fffffff
    s_add_u32 m0, s54, 61440
    s_nop 0
    buffer_load_dwordx4 v157, s[16:19], 0 offen nt lds
    s_add_u32 m0, s54, 62400
    s_nop 0
    buffer_load_dwordx4 v158, s[16:19], 0 offen nt lds
    s_mov_b32 exec_hi, -1
    ds_read_b128 v[24:27], v148 offset:32000
    ds_read_b128 v[28:31], v149 offset:34800
    ds_read_b64_tr_b16 v[56:57], v150 offset:32064
    ds_read_b64_tr_b16 v[58:59], v152 offset:34864
    ds_read_b64_tr_b16 v[60:61], v151 offset:32080
    ds_read_b64_tr_b16 v[62:63], v153 offset:34880
    s_mov_b64 exec, s[44:45]
    ds_read_b128 v[144:147], v154 offset:0
    s_mov_b64 exec, -1
    s_mov_b64 exec, s[46:47]
    v_cvt_pk_bf16_f32 v88, v104, v105
    s_mov_b64 exec, s[50:51]
    v_cvt_pk_bf16_f32 v90, v104, v105
    v_mov_b64 v[112:113], v[116:117]
    s_mov_b64 exec, s[48:49]
    v_cvt_pk_bf16_f32 v89, v106, v107
    s_mov_b64 exec, s[8:9]
    v_cvt_pk_bf16_f32 v91, v106, v107
    v_mov_b64 v[114:115], v[118:119]
    s_mov_b64 exec, -1
    v_exp_f32 v112, v112
    s_setprio 2
    v_mfma_f32_16x16x32_bf16 v[136:139], v[40:43], v[88:91], v[136:139]
    s_setprio 0
    v_exp_f32 v113, v113
    s_setprio 2
    v_mfma_f32_16x16x32_bf16 v[140:143], v[44:47], v[88:91], v[140:143]
    s_setprio 0
    v_exp_f32 v114, v114
    s_setprio 2
    s_waitcnt lgkmcnt(6)
    v_mfma_f32_16x16x32_bf16 v[120:123], v[24:27], v[164:167], v[84:87]
    s_setprio 0
    v_exp_f32 v115, v115
    s_setprio 2
    s_waitcnt lgkmcnt(5)
    v_mfma_f32_16x16x32_bf16 v[124:127], v[28:31], v[164:167], v[84:87]
    s_waitcnt lgkmcnt(0)
    v_mfma_f32_16x16x32_bf16 v[104:107], v[8:11], v[144:147], v[72:75]
    s_mov_b64 exec, s[46:47]
    s_setprio 0
    v_cvt_pk_bf16_f32 v92, v112, v113
    s_setprio 2
    v_mfma_f32_16x16x32_bf16 v[108:111], v[12:15], v[144:147], v[72:75]
    s_mov_b64 exec, s[50:51]
    s_setprio 0
    v_cvt_pk_bf16_f32 v94, v112, v113
    v_mov_b64 v[120:121], v[124:125]
    s_mov_b64 exec, s[48:49]
    v_cvt_pk_bf16_f32 v93, v114, v115
    s_mov_b64 exec, s[8:9]
    v_cvt_pk_bf16_f32 v95, v114, v115
    v_mov_b64 v[122:123], v[126:127]
    s_mov_b64 exec, -1
    v_exp_f32 v120, v120
    s_setprio 2
    v_mfma_f32_16x16x32_bf16 v[136:139], v[48:51], v[92:95], v[136:139]
    s_setprio 0
    v_exp_f32 v121, v121
    s_setprio 2
    v_mfma_f32_16x16x32_bf16 v[140:143], v[52:55], v[92:95], v[140:143]
    s_setprio 0
    v_exp_f32 v122, v122
    s_setprio 2
    v_mfma_f32_16x16x32_bf16 v[112:115], v[16:19], v[144:147], v[76:79]
    s_setprio 0
    v_exp_f32 v123, v123
    s_setprio 2
    v_mfma_f32_16x16x32_bf16 v[116:119], v[20:23], v[144:147], v[76:79]
    s_mov_b64 exec, s[46:47]
    s_setprio 0
    v_cvt_pk_bf16_f32 v96, v120, v121
    s_mov_b64 exec, s[50:51]
    v_cvt_pk_bf16_f32 v98, v120, v121
    v_mov_b64 v[104:105], v[108:109]
    s_mov_b64 exec, s[48:49]
    v_cvt_pk_bf16_f32 v97, v122, v123
    s_mov_b64 exec, s[8:9]
    v_cvt_pk_bf16_f32 v99, v122, v123
    v_mov_b64 v[106:107], v[110:111]
    s_mov_b64 exec, -1
    v_exp_f32 v104, v104
    s_setprio 2
    v_mfma_f32_16x16x32_bf16 v[136:139], v[56:59], v[96:99], v[136:139]
    s_setprio 0
    v_exp_f32 v105, v105
    s_setprio 2
    v_mfma_f32_16x16x32_bf16 v[140:143], v[60:63], v[96:99], v[140:143]
    s_setprio 0
    v_exp_f32 v106, v106
    s_setprio 2
    v_mfma_f32_16x16x32_bf16 v[120:123], v[24:27], v[144:147], v[80:83]
    s_setprio 0
    v_exp_f32 v107, v107
    s_setprio 2
    v_mfma_f32_16x16x32_bf16 v[124:127], v[28:31], v[144:147], v[80:83]
    s_mov_b64 exec, s[46:47]
    s_setprio 0
    v_cvt_pk_bf16_f32 v88, v104, v105
    s_mov_b64 exec, s[50:51]
    v_cvt_pk_bf16_f32 v90, v104, v105
    v_mov_b64 v[112:113], v[116:117]
    s_mov_b64 exec, s[48:49]
    v_cvt_pk_bf16_f32 v89, v106, v107
    s_mov_b64 exec, s[8:9]
    v_cvt_pk_bf16_f32 v91, v106, v107
    v_mov_b64 v[114:115], v[118:119]
    s_mov_b64 exec, -1
    v_permlane32_swap_b32 v140, v142
    v_permlane32_swap_b32 v141, v143
    v_rcp_f32 v160, v142
    s_nop 0
    v_max3_f32 v159, v159, v142, v160
    v_mul_f32 v136, v136, v160
    v_mul_f32 v137, v137, v160
    v_mul_f32 v138, v138, v160
    v_mul_f32 v139, v139, v160
    v_cvt_pk_bf16_f32 v136, v136, v137
    v_cvt_pk_bf16_f32 v137, v138, v139
    v_mul_f32 v140, v140, v160
    v_mul_f32 v141, v141, v160
    ds_write_b64 v155, v[136:137] offset:0
    v_cvt_pk_bf16_f32 v140, v140, v141
    ds_write_b32 v156, v140 offset:512
    v_exp_f32 v112, v112
    s_setprio 2
    v_mfma_f32_16x16x32_bf16 v[136:139], v[40:43], v[88:91], 0
    s_setprio 0
    v_exp_f32 v113, v113
    s_setprio 2
    v_mfma_f32_16x16x32_bf16 v[140:143], v[44:47], v[88:91], 0
    s_setprio 0
    v_exp_f32 v114, v114
    v_exp_f32 v115, v115
    s_waitcnt lgkmcnt(0)
    s_barrier
    ds_read_b128 v[32:35], v148 offset:48000
    ds_read_b128 v[36:39], v149 offset:50800
    ds_read_b64_tr_b16 v[64:65], v150 offset:48064
    ds_read_b64_tr_b16 v[66:67], v152 offset:50864
    ds_read_b64_tr_b16 v[68:69], v151 offset:48080
    ds_read_b64_tr_b16 v[70:71], v153 offset:50880
    s_mov_b64 exec, s[44:45]
    ds_read_b128 v[164:167], v154 offset:6144
    s_mov_b64 exec, -1
    s_mov_b64 exec, s[46:47]
    v_cvt_pk_bf16_f32 v92, v112, v113
    s_mov_b64 exec, s[50:51]
    v_cvt_pk_bf16_f32 v94, v112, v113
    v_mov_b64 v[120:121], v[124:125]
    s_mov_b64 exec, s[48:49]
    v_cvt_pk_bf16_f32 v93, v114, v115
    s_mov_b64 exec, s[8:9]
    v_cvt_pk_bf16_f32 v95, v114, v115
    v_mov_b64 v[122:123], v[126:127]
    s_mov_b64 exec, -1
    v_exp_f32 v120, v120
    s_setprio 2
    v_mfma_f32_16x16x32_bf16 v[136:139], v[48:51], v[92:95], v[136:139]
    s_setprio 0
    v_exp_f32 v121, v121
    s_setprio 2
    v_mfma_f32_16x16x32_bf16 v[140:143], v[52:55], v[92:95], v[140:143]
    s_setprio 0
    v_exp_f32 v122, v122
    s_setprio 2
    s_waitcnt lgkmcnt(6)
    v_mfma_f32_16x16x32_bf16 v[128:131], v[32:35], v[144:147], v[84:87]
    s_setprio 0
    v_exp_f32 v123, v123
    s_setprio 2
    s_waitcnt lgkmcnt(5)
    v_mfma_f32_16x16x32_bf16 v[132:135], v[36:39], v[144:147], v[84:87]
    s_waitcnt lgkmcnt(0)
    v_mfma_f32_16x16x32_bf16 v[112:115], v[16:19], v[164:167], v[72:75]
    s_mov_b64 exec, s[46:47]
    s_setprio 0
    v_cvt_pk_bf16_f32 v96, v120, v121
    s_setprio 2
    v_mfma_f32_16x16x32_bf16 v[116:119], v[20:23], v[164:167], v[72:75]
    s_mov_b64 exec, s[50:51]
    s_setprio 0
    v_cvt_pk_bf16_f32 v98, v120, v121
    v_mov_b64 v[128:129], v[132:133]
    s_mov_b64 exec, s[48:49]
    v_cvt_pk_bf16_f32 v97, v122, v123
    s_mov_b64 exec, s[8:9]
    v_cvt_pk_bf16_f32 v99, v122, v123
    v_mov_b64 v[130:131], v[134:135]
    s_mov_b64 exec, -1
    v_exp_f32 v128, v128
    s_setprio 2
    v_mfma_f32_16x16x32_bf16 v[136:139], v[56:59], v[96:99], v[136:139]
    s_setprio 0
    v_exp_f32 v129, v129
    s_setprio 2
    v_mfma_f32_16x16x32_bf16 v[140:143], v[60:63], v[96:99], v[140:143]
    s_setprio 0
    v_exp_f32 v130, v130
    s_setprio 2
    v_mfma_f32_16x16x32_bf16 v[120:123], v[24:27], v[164:167], v[76:79]
    s_setprio 0
    v_exp_f32 v131, v131
    s_setprio 2
    v_mfma_f32_16x16x32_bf16 v[124:127], v[28:31], v[164:167], v[76:79]
    s_mov_b64 exec, s[46:47]
    s_setprio 0
    v_cvt_pk_bf16_f32 v100, v128, v129
    s_mov_b64 exec, s[50:51]
    v_cvt_pk_bf16_f32 v102, v128, v129
    v_mov_b64 v[112:113], v[116:117]
    s_mov_b64 exec, s[48:49]
    v_cvt_pk_bf16_f32 v101, v130, v131
    s_mov_b64 exec, s[8:9]
    v_cvt_pk_bf16_f32 v103, v130, v131
    v_mov_b64 v[114:115], v[118:119]
    s_mov_b64 exec, -1
    v_exp_f32 v112, v112
    s_setprio 2
    v_mfma_f32_16x16x32_bf16 v[136:139], v[64:67], v[100:103], v[136:139]
    s_setprio 0
    v_exp_f32 v113, v113
    s_setprio 2
    v_mfma_f32_16x16x32_bf16 v[140:143], v[68:71], v[100:103], v[140:143]
    s_setprio 0
    v_exp_f32 v114, v114
    s_setprio 2
    v_mfma_f32_16x16x32_bf16 v[128:131], v[32:35], v[164:167], v[80:83]
    s_setprio 0
    v_exp_f32 v115, v115
    s_setprio 2
    v_mfma_f32_16x16x32_bf16 v[132:135], v[36:39], v[164:167], v[80:83]
    s_mov_b64 exec, s[46:47]
    s_setprio 0
    v_cvt_pk_bf16_f32 v92, v112, v113
    s_mov_b64 exec, s[50:51]
    v_cvt_pk_bf16_f32 v94, v112, v113
    v_mov_b64 v[120:121], v[124:125]
    s_mov_b64 exec, s[48:49]
    v_cvt_pk_bf16_f32 v93, v114, v115
    s_mov_b64 exec, s[8:9]
    v_cvt_pk_bf16_f32 v95, v114, v115
    v_mov_b64 v[122:123], v[126:127]
    s_mov_b64 exec, -1
    v_permlane32_swap_b32 v140, v142
    v_permlane32_swap_b32 v141, v143
    v_rcp_f32 v160, v142
    s_nop 0
    v_max3_f32 v159, v159, v142, v160
    v_mul_f32 v136, v136, v160
    v_mul_f32 v137, v137, v160
    v_mul_f32 v138, v138, v160
    v_mul_f32 v139, v139, v160
    v_cvt_pk_bf16_f32 v136, v136, v137
    v_cvt_pk_bf16_f32 v137, v138, v139
    v_mul_f32 v140, v140, v160
    v_mul_f32 v141, v141, v160
    ds_write_b64 v155, v[136:137] offset:6144
    v_cvt_pk_bf16_f32 v140, v140, v141
    ds_write_b32 v156, v140 offset:6656
    v_exp_f32 v120, v120
    s_setprio 2
    v_mfma_f32_16x16x32_bf16 v[136:139], v[48:51], v[92:95], 0
    s_setprio 0
    v_exp_f32 v121, v121
    s_setprio 2
    v_mfma_f32_16x16x32_bf16 v[140:143], v[52:55], v[92:95], 0
    s_setprio 0
    v_exp_f32 v122, v122
    v_exp_f32 v123, v123
    s_waitcnt vmcnt(0) lgkmcnt(0)
    s_barrier
    ds_read_b128 v[8:11], v148 offset:0
    ds_read_b128 v[12:15], v149 offset:2800
    ds_read_b64_tr_b16 v[40:41], v150 offset:64
    ds_read_b64_tr_b16 v[42:43], v152 offset:2864
    ds_read_b64_tr_b16 v[44:45], v151 offset:80
    ds_read_b64_tr_b16 v[46:47], v153 offset:2880
    s_mov_b64 exec, s[44:45]
    ds_read_b128 v[144:147], v154 offset:12288
    s_mov_b64 exec, -1
    s_mov_b64 exec, s[46:47]
    v_cvt_pk_bf16_f32 v96, v120, v121
    s_mov_b64 exec, s[50:51]
    v_cvt_pk_bf16_f32 v98, v120, v121
    v_mov_b64 v[128:129], v[132:133]
    s_mov_b64 exec, s[48:49]
    v_cvt_pk_bf16_f32 v97, v122, v123
    s_mov_b64 exec, s[8:9]
    v_cvt_pk_bf16_f32 v99, v122, v123
    v_mov_b64 v[130:131], v[134:135]
    s_mov_b64 exec, -1
    v_exp_f32 v128, v128
    s_setprio 2
    v_mfma_f32_16x16x32_bf16 v[136:139], v[56:59], v[96:99], v[136:139]
    s_setprio 0
    v_exp_f32 v129, v129
    s_setprio 2
    v_mfma_f32_16x16x32_bf16 v[140:143], v[60:63], v[96:99], v[140:143]
    s_setprio 0
    v_exp_f32 v130, v130
    s_setprio 2
    s_waitcnt lgkmcnt(6)
    v_mfma_f32_16x16x32_bf16 v[104:107], v[8:11], v[164:167], v[84:87]
    s_setprio 0
    v_exp_f32 v131, v131
    s_setprio 2
    s_waitcnt lgkmcnt(5)
    v_mfma_f32_16x16x32_bf16 v[108:111], v[12:15], v[164:167], v[84:87]
    s_waitcnt lgkmcnt(0)
    v_mfma_f32_16x16x32_bf16 v[120:123], v[24:27], v[144:147], v[72:75]
    s_mov_b64 exec, s[46:47]
    s_setprio 0
    v_cvt_pk_bf16_f32 v100, v128, v129
    s_setprio 2
    v_mfma_f32_16x16x32_bf16 v[124:127], v[28:31], v[144:147], v[72:75]
    s_mov_b64 exec, s[50:51]
    s_setprio 0
    v_cvt_pk_bf16_f32 v102, v128, v129
    v_mov_b64 v[104:105], v[108:109]
    s_mov_b64 exec, s[48:49]
    v_cvt_pk_bf16_f32 v101, v130, v131
    s_mov_b64 exec, s[8:9]
    v_cvt_pk_bf16_f32 v103, v130, v131
    v_mov_b64 v[106:107], v[110:111]
    s_mov_b64 exec, -1
    v_exp_f32 v104, v104
    s_setprio 2
    v_mfma_f32_16x16x32_bf16 v[136:139], v[64:67], v[100:103], v[136:139]
    s_setprio 0
    v_exp_f32 v105, v105
    s_setprio 2
    v_mfma_f32_16x16x32_bf16 v[140:143], v[68:71], v[100:103], v[140:143]
    s_setprio 0
    v_exp_f32 v106, v106
    s_setprio 2
    v_mfma_f32_16x16x32_bf16 v[128:131], v[32:35], v[144:147], v[76:79]
    s_setprio 0
    v_exp_f32 v107, v107
    s_setprio 2
    v_mfma_f32_16x16x32_bf16 v[132:135], v[36:39], v[144:147], v[76:79]
    s_mov_b64 exec, s[46:47]
    s_setprio 0
    v_cvt_pk_bf16_f32 v88, v104, v105
    s_mov_b64 exec, s[50:51]
    v_cvt_pk_bf16_f32 v90, v104, v105
    v_mov_b64 v[120:121], v[124:125]
    s_mov_b64 exec, s[48:49]
    v_cvt_pk_bf16_f32 v89, v106, v107
    s_mov_b64 exec, s[8:9]
    v_cvt_pk_bf16_f32 v91, v106, v107
    v_mov_b64 v[122:123], v[126:127]
    s_mov_b64 exec, -1
    v_exp_f32 v120, v120
    s_setprio 2
    v_mfma_f32_16x16x32_bf16 v[136:139], v[40:43], v[88:91], v[136:139]
    s_setprio 0
    v_exp_f32 v121, v121
    s_setprio 2
    v_mfma_f32_16x16x32_bf16 v[140:143], v[44:47], v[88:91], v[140:143]
    s_setprio 0
    v_exp_f32 v122, v122
    s_setprio 2
    v_mfma_f32_16x16x32_bf16 v[104:107], v[8:11], v[144:147], v[80:83]
    s_setprio 0
    v_exp_f32 v123, v123
    s_setprio 2
    v_mfma_f32_16x16x32_bf16 v[108:111], v[12:15], v[144:147], v[80:83]
    s_mov_b64 exec, s[46:47]
    s_setprio 0
    v_cvt_pk_bf16_f32 v96, v120, v121
    s_mov_b64 exec, s[50:51]
    v_cvt_pk_bf16_f32 v98, v120, v121
    v_mov_b64 v[128:129], v[132:133]
    s_mov_b64 exec, s[48:49]
    v_cvt_pk_bf16_f32 v97, v122, v123
    s_mov_b64 exec, s[8:9]
    v_cvt_pk_bf16_f32 v99, v122, v123
    v_mov_b64 v[130:131], v[134:135]
    s_mov_b64 exec, -1
    v_permlane32_swap_b32 v140, v142
    v_permlane32_swap_b32 v141, v143
    v_rcp_f32 v160, v142
    s_nop 0
    v_max3_f32 v159, v159, v142, v160
    v_mul_f32 v136, v136, v160
    v_mul_f32 v137, v137, v160
    v_mul_f32 v138, v138, v160
    v_mul_f32 v139, v139, v160
    v_cvt_pk_bf16_f32 v136, v136, v137
    v_cvt_pk_bf16_f32 v137, v138, v139
    v_mul_f32 v140, v140, v160
    v_mul_f32 v141, v141, v160
    ds_write_b64 v155, v[136:137] offset:12288
    v_cvt_pk_bf16_f32 v140, v140, v141
    ds_write_b32 v156, v140 offset:12800
    v_exp_f32 v128, v128
    s_setprio 2
    v_mfma_f32_16x16x32_bf16 v[136:139], v[56:59], v[96:99], 0
    s_setprio 0
    v_exp_f32 v129, v129
    s_setprio 2
    v_mfma_f32_16x16x32_bf16 v[140:143], v[60:63], v[96:99], 0
    s_setprio 0
    v_exp_f32 v130, v130
    v_exp_f32 v131, v131
    s_waitcnt lgkmcnt(0)
    s_barrier
    ds_read_b128 v[16:19], v148 offset:16000
    ds_read_b128 v[20:23], v149 offset:18800
    ds_read_b64_tr_b16 v[48:49], v150 offset:16064
    ds_read_b64_tr_b16 v[50:51], v152 offset:18864
    ds_read_b64_tr_b16 v[52:53], v151 offset:16080
    ds_read_b64_tr_b16 v[54:55], v153 offset:18880
    s_mov_b64 exec, s[44:45]
    ds_read_b128 v[164:167], v154 offset:0
    s_mov_b64 exec, -1
    s_mov_b64 exec, s[46:47]
    v_cvt_pk_bf16_f32 v100, v128, v129
    s_mov_b64 exec, s[50:51]
    v_cvt_pk_bf16_f32 v102, v128, v129
    v_mov_b64 v[104:105], v[108:109]
    s_mov_b64 exec, s[48:49]
    v_cvt_pk_bf16_f32 v101, v130, v131
    s_mov_b64 exec, s[8:9]
    v_cvt_pk_bf16_f32 v103, v130, v131
    v_mov_b64 v[106:107], v[110:111]
    s_mov_b64 exec, -1
    v_exp_f32 v104, v104
    s_setprio 2
    v_mfma_f32_16x16x32_bf16 v[136:139], v[64:67], v[100:103], v[136:139]
    s_setprio 0
    v_exp_f32 v105, v105
    s_setprio 2
    v_mfma_f32_16x16x32_bf16 v[140:143], v[68:71], v[100:103], v[140:143]
    s_setprio 0
    v_exp_f32 v106, v106
    s_setprio 2
    s_waitcnt lgkmcnt(6)
    v_mfma_f32_16x16x32_bf16 v[112:115], v[16:19], v[144:147], v[84:87]
    s_setprio 0
    v_exp_f32 v107, v107
    s_setprio 2
    s_waitcnt lgkmcnt(5)
    v_mfma_f32_16x16x32_bf16 v[116:119], v[20:23], v[144:147], v[84:87]
    s_cmp_eq_u32 s38, 0
    s_cbranch_scc1 L_e5f
    ds_read2_b32 v[72:73], v1 offset0:34 offset1:51
    ds_read2_b32 v[74:75], v2 offset0:35 offset1:52
    s_setprio 0
    v_mov_b32 v85, 0xff800000
    v_mov_b32 v87, 0xff800000
L_e5f:
    s_setprio 2
    s_waitcnt lgkmcnt(0)
    v_mfma_f32_16x16x32_bf16 v[128:131], v[32:35], v[164:167], v[72:75]
    s_mov_b64 exec, s[46:47]
    s_setprio 0
    v_cvt_pk_bf16_f32 v88, v104, v105
    s_setprio 2
    v_mfma_f32_16x16x32_bf16 v[132:135], v[36:39], v[164:167], v[72:75]
    s_mov_b64 exec, s[50:51]
    s_setprio 0
    v_cvt_pk_bf16_f32 v90, v104, v105
    v_mov_b64 v[112:113], v[116:117]
    s_mov_b64 exec, s[48:49]
    v_cvt_pk_bf16_f32 v89, v106, v107
    s_mov_b64 exec, s[8:9]
    v_cvt_pk_bf16_f32 v91, v106, v107
    v_mov_b64 v[114:115], v[118:119]
    s_mov_b64 exec, -1
    v_exp_f32 v112, v112
    s_setprio 2
    v_mfma_f32_16x16x32_bf16 v[136:139], v[40:43], v[88:91], v[136:139]
    s_setprio 0
    v_exp_f32 v113, v113
    s_setprio 2
    v_mfma_f32_16x16x32_bf16 v[140:143], v[44:47], v[88:91], v[140:143]
    s_setprio 0
    v_exp_f32 v114, v114
    s_setprio 2
    v_mfma_f32_16x16x32_bf16 v[104:107], v[8:11], v[164:167], v[76:79]
    s_setprio 0
    v_exp_f32 v115, v115
    s_setprio 2
    v_mfma_f32_16x16x32_bf16 v[108:111], v[12:15], v[164:167], v[76:79]
    s_mov_b64 exec, s[46:47]
    s_setprio 0
    v_cvt_pk_bf16_f32 v92, v112, v113
    s_mov_b64 exec, s[50:51]
    v_cvt_pk_bf16_f32 v94, v112, v113
    v_mov_b64 v[128:129], v[132:133]
    s_mov_b64 exec, s[48:49]
    v_cvt_pk_bf16_f32 v93, v114, v115
    s_mov_b64 exec, s[8:9]
    v_cvt_pk_bf16_f32 v95, v114, v115
    v_mov_b64 v[130:131], v[134:135]
    s_mov_b64 exec, -1
    v_exp_f32 v128, v128
    s_setprio 2
    v_mfma_f32_16x16x32_bf16 v[136:139], v[48:51], v[92:95], v[136:139]
    s_setprio 0
    v_exp_f32 v129, v129
    s_setprio 2
    v_mfma_f32_16x16x32_bf16 v[140:143], v[52:55], v[92:95], v[140:143]
    s_setprio 0
    v_exp_f32 v130, v130
    s_setprio 2
    v_mfma_f32_16x16x32_bf16 v[112:115], v[16:19], v[164:167], v[80:83]
    s_setprio 0
    v_exp_f32 v131, v131
    s_setprio 2
    v_mfma_f32_16x16x32_bf16 v[116:119], v[20:23], v[164:167], v[80:83]
    s_mov_b64 exec, s[46:47]
    s_setprio 0
    v_cvt_pk_bf16_f32 v100, v128, v129
    s_mov_b64 exec, s[50:51]
    v_cvt_pk_bf16_f32 v102, v128, v129
    v_mov_b64 v[104:105], v[108:109]
    s_mov_b64 exec, s[48:49]
    v_cvt_pk_bf16_f32 v101, v130, v131
    s_mov_b64 exec, s[8:9]
    v_cvt_pk_bf16_f32 v103, v130, v131
    v_mov_b64 v[106:107], v[110:111]
    s_mov_b64 exec, -1
    v_permlane32_swap_b32 v140, v142
    v_permlane32_swap_b32 v141, v143
    v_rcp_f32 v160, v142
    s_nop 0
    v_max3_f32 v159, v159, v142, v160
    v_mul_f32 v136, v136, v160
    v_mul_f32 v137, v137, v160
    v_mul_f32 v138, v138, v160
    v_mul_f32 v139, v139, v160
    v_cvt_pk_bf16_f32 v136, v136, v137
    v_cvt_pk_bf16_f32 v137, v138, v139
    v_mul_f32 v140, v140, v160
    v_mul_f32 v141, v141, v160
    ds_write_b64 v155, v[136:137] offset:0
    v_cvt_pk_bf16_f32 v140, v140, v141
    ds_write_b32 v156, v140 offset:512
    v_exp_f32 v104, v104
    s_setprio 2
    v_mfma_f32_16x16x32_bf16 v[136:139], v[64:67], v[100:103], 0
    s_setprio 0
    v_exp_f32 v105, v105
    s_setprio 2
    v_mfma_f32_16x16x32_bf16 v[140:143], v[68:71], v[100:103], 0
    s_setprio 0
    v_exp_f32 v106, v106
    v_exp_f32 v107, v107
    s_waitcnt lgkmcnt(0)
    s_barrier
    ds_read_b128 v[24:27], v148 offset:32000
    ds_read_b128 v[28:31], v149 offset:34800
    ds_read_b64_tr_b16 v[56:57], v150 offset:32064
    ds_read_b64_tr_b16 v[58:59], v152 offset:34864
    ds_read_b64_tr_b16 v[60:61], v151 offset:32080
    ds_read_b64_tr_b16 v[62:63], v153 offset:34880
    s_mov_b64 exec, s[44:45]
    ds_read_b128 v[144:147], v154 offset:6144
    s_mov_b64 exec, -1
    s_mov_b64 exec, s[46:47]
    s_setprio 1
    v_cvt_pk_bf16_f32 v88, v104, v105
    s_mov_b64 exec, s[50:51]
    v_cvt_pk_bf16_f32 v90, v104, v105
    v_mov_b64 v[112:113], v[116:117]
    s_mov_b64 exec, s[48:49]
    v_cvt_pk_bf16_f32 v89, v106, v107
    s_mov_b64 exec, s[8:9]
    v_cvt_pk_bf16_f32 v91, v106, v107
    v_mov_b64 v[114:115], v[118:119]
    s_mov_b64 exec, -1
    v_exp_f32 v112, v112
    v_mfma_f32_16x16x32_bf16 v[136:139], v[40:43], v[88:91], v[136:139]
    v_exp_f32 v113, v113
    v_mfma_f32_16x16x32_bf16 v[140:143], v[44:47], v[88:91], v[140:143]
    v_exp_f32 v114, v114
    s_waitcnt lgkmcnt(6)
    v_mfma_f32_16x16x32_bf16 v[120:123], v[24:27], v[164:167], v[84:87]
    v_exp_f32 v115, v115
    s_waitcnt lgkmcnt(5)
    v_mfma_f32_16x16x32_bf16 v[124:127], v[28:31], v[164:167], v[84:87]
    s_cmp_eq_u32 s38, 0
    s_cbranch_scc1 L_e6f
    ds_read2_b32 v[84:85], v1 offset0:0 offset1:17
    ds_read2_b32 v[86:87], v2 offset0:1 offset1:18
    v_mov_b32 v81, 0xff800000
    v_mov_b32 v83, 0xff800000
L_e6f:
    s_cmp_lg_u32 s38, 0
    s_cbranch_scc1 L_s9f
    ds_read_b128 v[32:35], v148 offset:48000
    ds_read_b128 v[36:39], v149 offset:50800
    ds_read_b64_tr_b16 v[64:65], v150 offset:48064
    ds_read_b64_tr_b16 v[66:67], v152 offset:50864
    ds_read_b64_tr_b16 v[68:69], v151 offset:48080
    ds_read_b64_tr_b16 v[70:71], v153 offset:50880
L_s9f:
    s_waitcnt lgkmcnt(0)
    v_mfma_f32_16x16x32_bf16 v[104:107], v[8:11], v[144:147], v[72:75]
    s_mov_b64 exec, s[46:47]
    v_cvt_pk_bf16_f32 v92, v112, v113
    v_mfma_f32_16x16x32_bf16 v[108:111], v[12:15], v[144:147], v[72:75]
    s_mov_b64 exec, s[50:51]
    v_cvt_pk_bf16_f32 v94, v112, v113
    v_mov_b64 v[120:121], v[124:125]
    s_mov_b64 exec, s[48:49]
    v_cvt_pk_bf16_f32 v93, v114, v115
    s_mov_b64 exec, s[8:9]
    v_cvt_pk_bf16_f32 v95, v114, v115
    v_mov_b64 v[122:123], v[126:127]
    s_mov_b64 exec, -1
    v_exp_f32 v120, v120
    v_mfma_f32_16x16x32_bf16 v[136:139], v[48:51], v[92:95], v[136:139]
    v_exp_f32 v121, v121
    v_mfma_f32_16x16x32_bf16 v[140:143], v[52:55], v[92:95], v[140:143]
    v_exp_f32 v122, v122
    v_mfma_f32_16x16x32_bf16 v[112:115], v[16:19], v[144:147], v[76:79]
    v_exp_f32 v123, v123
    v_mfma_f32_16x16x32_bf16 v[116:119], v[20:23], v[144:147], v[76:79]
    s_mov_b64 exec, s[46:47]
    v_cvt_pk_bf16_f32 v96, v120, v121
    s_mov_b64 exec, s[50:51]
    v_cvt_pk_bf16_f32 v98, v120, v121
    v_mov_b64 v[104:105], v[108:109]
    s_mov_b64 exec, s[48:49]
    v_cvt_pk_bf16_f32 v97, v122, v123
    s_mov_b64 exec, s[8:9]
    v_cvt_pk_bf16_f32 v99, v122, v123
    v_mov_b64 v[106:107], v[110:111]
    s_mov_b64 exec, -1
    v_exp_f32 v104, v104
    v_mfma_f32_16x16x32_bf16 v[136:139], v[56:59], v[96:99], v[136:139]
    v_exp_f32 v105, v105
    v_mfma_f32_16x16x32_bf16 v[140:143], v[60:63], v[96:99], v[140:143]
    v_exp_f32 v106, v106
    v_mfma_f32_16x16x32_bf16 v[120:123], v[24:27], v[144:147], v[80:83]
    v_exp_f32 v107, v107
    v_mfma_f32_16x16x32_bf16 v[124:127], v[28:31], v[144:147], v[80:83]
    s_mov_b64 exec, s[46:47]
    v_cvt_pk_bf16_f32 v88, v104, v105
    s_mov_b64 exec, s[50:51]
    v_cvt_pk_bf16_f32 v90, v104, v105
    s_waitcnt lgkmcnt(5)
    v_mfma_f32_16x16x32_bf16 v[128:131], v[32:35], v[144:147], v[84:87]
    v_mov_b64 v[112:113], v[116:117]
    s_mov_b64 exec, s[48:49]
    v_cvt_pk_bf16_f32 v89, v106, v107
    s_waitcnt lgkmcnt(4)
    v_mfma_f32_16x16x32_bf16 v[132:135], v[36:39], v[144:147], v[84:87]
    s_mov_b64 exec, s[8:9]
    v_cvt_pk_bf16_f32 v91, v106, v107
    v_mov_b64 v[114:115], v[118:119]
    s_mov_b64 exec, -1
    v_permlane32_swap_b32 v140, v142
    v_permlane32_swap_b32 v141, v143
    v_rcp_f32 v160, v142
    s_nop 0
    v_max3_f32 v159, v159, v142, v160
    v_mul_f32 v136, v136, v160
    v_mul_f32 v137, v137, v160
    v_mul_f32 v138, v138, v160
    v_mul_f32 v139, v139, v160
    v_cvt_pk_bf16_f32 v136, v136, v137
    v_cvt_pk_bf16_f32 v137, v138, v139
    v_mul_f32 v140, v140, v160
    v_mul_f32 v141, v141, v160
    ds_write_b64 v155, v[136:137] offset:6144
    v_cvt_pk_bf16_f32 v140, v140, v141
    ds_write_b32 v156, v140 offset:6656
    v_exp_f32 v112, v112
    v_mfma_f32_16x16x32_bf16 v[136:139], v[40:43], v[88:91], 0
    v_exp_f32 v113, v113
    v_mfma_f32_16x16x32_bf16 v[140:143], v[44:47], v[88:91], 0
    v_exp_f32 v114, v114
    v_exp_f32 v115, v115
    s_mov_b64 exec, s[46:47]
    v_cvt_pk_bf16_f32 v92, v112, v113
    s_mov_b64 exec, s[50:51]
    v_cvt_pk_bf16_f32 v94, v112, v113
    v_mov_b64 v[120:121], v[124:125]
    s_mov_b64 exec, s[48:49]
    v_cvt_pk_bf16_f32 v93, v114, v115
    s_mov_b64 exec, s[8:9]
    v_cvt_pk_bf16_f32 v95, v114, v115
    v_mov_b64 v[122:123], v[126:127]
    s_mov_b64 exec, -1
    v_exp_f32 v120, v120
    v_mfma_f32_16x16x32_bf16 v[136:139], v[48:51], v[92:95], v[136:139]
    v_exp_f32 v121, v121
    v_mfma_f32_16x16x32_bf16 v[140:143], v[52:55], v[92:95], v[140:143]
    v_exp_f32 v122, v122
    v_exp_f32 v123, v123
    s_mov_b64 exec, s[46:47]
    v_cvt_pk_bf16_f32 v96, v120, v121
    s_mov_b64 exec, s[50:51]
    v_cvt_pk_bf16_f32 v98, v120, v121
    v_mov_b64 v[128:129], v[132:133]
    s_mov_b64 exec, s[48:49]
    v_cvt_pk_bf16_f32 v97, v122, v123
    s_mov_b64 exec, s[8:9]
    v_cvt_pk_bf16_f32 v99, v122, v123
    v_mov_b64 v[130:131], v[134:135]
    s_mov_b64 exec, -1
    v_mfma_f32_16x16x32_bf16 v[136:139], v[56:59], v[96:99], v[136:139]
    v_mfma_f32_16x16x32_bf16 v[140:143], v[60:63], v[96:99], v[140:143]
    s_waitcnt lgkmcnt(0)
    s_barrier
    s_setprio 0
    v_exp_f32 v128, v128
    v_exp_f32 v129, v129
    v_exp_f32 v130, v130
    v_exp_f32 v131, v131
    s_mov_b64 exec, s[46:47]
    v_cvt_pk_bf16_f32 v100, v128, v129
    s_mov_b64 exec, s[50:51]
    v_cvt_pk_bf16_f32 v102, v128, v129
    s_mov_b64 exec, s[48:49]
    v_cvt_pk_bf16_f32 v101, v130, v131
    s_mov_b64 exec, s[8:9]
    v_cvt_pk_bf16_f32 v103, v130, v131
    s_mov_b64 exec, -1
    s_setprio 2
    v_mfma_f32_16x16x32_bf16 v[136:139], v[64:67], v[100:103], v[136:139]
    v_mfma_f32_16x16x32_bf16 v[140:143], v[68:71], v[100:103], v[140:143]
    s_setprio 0
    s_nop 6
    v_permlane32_swap_b32 v140, v142
    v_permlane32_swap_b32 v141, v143
    v_rcp_f32 v160, v142
    s_nop 0
    v_max3_f32 v159, v159, v142, v160
    v_mul_f32 v136, v136, v160
    v_mul_f32 v137, v137, v160
    v_mul_f32 v138, v138, v160
    v_mul_f32 v139, v139, v160
    v_cvt_pk_bf16_f32 v136, v136, v137
    v_cvt_pk_bf16_f32 v137, v138, v139
    v_mul_f32 v140, v140, v160
    v_mul_f32 v141, v141, v160
    ds_write_b64 v155, v[136:137] offset:12288
    v_cvt_pk_bf16_f32 v140, v140, v141
    ds_write_b32 v156, v140 offset:12800
    s_waitcnt lgkmcnt(0)
    s_barrier
    v_mov_b32 v161, 0x5d800000
    v_cmp_gt_f32 vcc, v159, v161
    v_mov_b32 v162, 0
    s_and_b64 exec, vcc, exec
    ds_write_b32 v162, v161
    s_mov_b64 exec, -1
    s_branch L_fin
L_attg:
    ds_read_b128 v[8:11], v148 offset:0
    ds_read_b128 v[12:15], v149 offset:2800
    ds_read_b128 v[16:19], v148 offset:16000
    ds_read_b128 v[20:23], v149 offset:18800
    s_setprio 3
    v_mfma_f32_16x16x32_bf16 v[136:139], v[56:59], v[96:99], 0
    v_mfma_f32_16x16x32_bf16 v[140:143], v[60:63], v[96:99], 0
    s_setprio 1
    v_exp_f32 v128, v128
    v_exp_f32 v129, v129
    s_mov_b64 exec, s[44:45]
    ds_read_b128 v[164:167], v154 offset:12288
    s_mov_b64 exec, -1
    v_exp_f32 v130, v130
    s_setprio 3
    s_waitcnt lgkmcnt(4)
    v_mfma_f32_16x16x32_bf16 v[104:107], v[8:11], v[144:147], v[80:83]
    s_setprio 1
    v_exp_f32 v131, v131
    s_setprio 3
    s_waitcnt lgkmcnt(3)
    v_mfma_f32_16x16x32_bf16 v[108:111], v[12:15], v[144:147], v[80:83]
    s_waitcnt lgkmcnt(2)
    v_mfma_f32_16x16x32_bf16 v[112:115], v[16:19], v[144:147], v[84:87]
    ds_read_b64_tr_b16 v[40:41], v150 offset:64
    s_waitcnt lgkmcnt(2)
    v_mfma_f32_16x16x32_bf16 v[116:119], v[20:23], v[144:147], v[84:87]
    ds_read_b64_tr_b16 v[42:43], v152 offset:2864
    ds_read_b64_tr_b16 v[44:45], v151 offset:80
    ds_read_b64_tr_b16 v[46:47], v153 offset:2880
    s_mov_b64 exec, s[46:47]
    s_setprio 1
    v_cvt_pk_bf16_f32 v100, v128, v129
    s_mov_b64 exec, s[50:51]
    v_cvt_pk_bf16_f32 v102, v128, v129
    v_mov_b64 v[104:105], v[108:109]
    s_mov_b64 exec, s[48:49]
    v_cvt_pk_bf16_f32 v101, v130, v131
    s_mov_b64 exec, s[8:9]
    v_cvt_pk_bf16_f32 v103, v130, v131
    v_mov_b64 v[106:107], v[110:111]
    s_mov_b64 exec, -1
    v_exp_f32 v104, v104
    s_setprio 3
    v_mfma_f32_16x16x32_bf16 v[136:139], v[64:67], v[100:103], v[136:139]
    s_setprio 1
    v_exp_f32 v105, v105
    s_setprio 3
    v_mfma_f32_16x16x32_bf16 v[140:143], v[68:71], v[100:103], v[140:143]
    s_setprio 1
    v_exp_f32 v106, v106
    v_exp_f32 v107, v107
    ds_read_b64_tr_b16 v[48:49], v150 offset:16064
    ds_read_b64_tr_b16 v[50:51], v152 offset:18864
    ds_read_b64_tr_b16 v[52:53], v151 offset:16080
    ds_read_b64_tr_b16 v[54:55], v153 offset:18880
    s_setprio 3
    s_waitcnt lgkmcnt(8)
    v_mfma_f32_16x16x32_bf16 v[128:131], v[32:35], v[164:167], v[72:75]
    s_mov_b64 exec, s[46:47]
    s_setprio 1
    v_cvt_pk_bf16_f32 v88, v104, v105
    s_setprio 3
    v_mfma_f32_16x16x32_bf16 v[132:135], v[36:39], v[164:167], v[72:75]
    s_mov_b64 exec, s[50:51]
    s_setprio 1
    v_cvt_pk_bf16_f32 v90, v104, v105
    v_mov_b64 v[112:113], v[116:117]
    s_mov_b64 exec, s[48:49]
    v_cvt_pk_bf16_f32 v89, v106, v107
    s_mov_b64 exec, s[8:9]
    v_cvt_pk_bf16_f32 v91, v106, v107
    v_mov_b64 v[114:115], v[118:119]
    s_mov_b64 exec, -1
    v_exp_f32 v112, v112
    s_setprio 3
    s_waitcnt lgkmcnt(6)
    v_mfma_f32_16x16x32_bf16 v[136:139], v[40:43], v[88:91], v[136:139]
    s_setprio 1
    v_exp_f32 v113, v113
    s_setprio 3
    s_waitcnt lgkmcnt(4)
    v_mfma_f32_16x16x32_bf16 v[140:143], v[44:47], v[88:91], v[140:143]
    s_setprio 1
    v_exp_f32 v114, v114
    s_setprio 3
    v_mfma_f32_16x16x32_bf16 v[104:107], v[8:11], v[164:167], v[76:79]
    s_setprio 1
    v_exp_f32 v115, v115
    s_setprio 3
    v_mfma_f32_16x16x32_bf16 v[108:111], v[12:15], v[164:167], v[76:79]
    s_mov_b64 exec, s[46:47]
    s_setprio 1
    v_cvt_pk_bf16_f32 v92, v112, v113
    s_mov_b64 exec, s[50:51]
    v_cvt_pk_bf16_f32 v94, v112, v113
    v_mov_b64 v[128:129], v[132:133]
    s_mov_b64 exec, s[48:49]
    v_cvt_pk_bf16_f32 v93, v114, v115
    s_mov_b64 exec, s[8:9]
    v_cvt_pk_bf16_f32 v95, v114, v115
    v_mov_b64 v[130:131], v[134:135]
    s_mov_b64 exec, -1
    v_exp_f32 v128, v128
    s_setprio 3
    s_waitcnt lgkmcnt(2)
    v_mfma_f32_16x16x32_bf16 v[136:139], v[48:51], v[92:95], v[136:139]
    s_setprio 1
    v_exp_f32 v129, v129
    s_setprio 3
    s_waitcnt lgkmcnt(0)
    v_mfma_f32_16x16x32_bf16 v[140:143], v[52:55], v[92:95], v[140:143]
    s_setprio 1
    v_exp_f32 v130, v130
    s_setprio 3
    v_mfma_f32_16x16x32_bf16 v[112:115], v[16:19], v[164:167], v[80:83]
    s_setprio 1
    v_exp_f32 v131, v131
    s_setprio 3
    v_mfma_f32_16x16x32_bf16 v[116:119], v[20:23], v[164:167], v[80:83]
    s_mov_b64 exec, s[46:47]
    s_setprio 1
    v_cvt_pk_bf16_f32 v100, v128, v129
    s_mov_b64 exec, s[50:51]
    v_cvt_pk_bf16_f32 v102, v128, v129
    v_mov_b64 v[104:105], v[108:109]
    s_mov_b64 exec, s[48:49]
    v_cvt_pk_bf16_f32 v101, v130, v131
    s_mov_b64 exec, s[8:9]
    v_cvt_pk_bf16_f32 v103, v130, v131
    s_setprio 0
    v_mov_b64 v[106:107], v[110:111]
    s_mov_b64 exec, -1
    v_permlane32_swap_b32 v140, v142
    v_permlane32_swap_b32 v141, v143
    v_rcp_f32 v160, v142
    s_nop 0
    v_max3_f32 v159, v159, v142, v160
    v_mul_f32 v136, v136, v160
    v_mul_f32 v137, v137, v160
    v_mul_f32 v138, v138, v160
    v_mul_f32 v139, v139, v160
    v_cvt_pk_bf16_f32 v136, v136, v137
    v_cvt_pk_bf16_f32 v137, v138, v139
    v_mul_f32 v140, v140, v160
    v_mul_f32 v141, v141, v160
    ds_write_b64 v155, v[136:137] offset:12288
    v_cvt_pk_bf16_f32 v140, v140, v141
    ds_write_b32 v156, v140 offset:12800
    v_exp_f32 v104, v104
    s_setprio 2
    v_mfma_f32_16x16x32_bf16 v[136:139], v[64:67], v[100:103], 0
    s_setprio 0
    v_exp_f32 v105, v105
    s_setprio 2
    v_mfma_f32_16x16x32_bf16 v[140:143], v[68:71], v[100:103], 0
    s_setprio 0
    v_exp_f32 v106, v106
    v_exp_f32 v107, v107
    s_waitcnt vmcnt(0) lgkmcnt(0)
    s_barrier
    s_mul_i32 s61, s41, 4
    s_add_u32 s61, s61, s40
    v_add_u32 v157, s61, v157
    s_add_u32 s61, s61, 1920
    v_add_u32 v158, s61, v158
    s_mov_b32 exec_hi, 0x0fffffff
    s_add_u32 m0, s54, 61440
    s_nop 0
    buffer_load_dwordx4 v157, s[16:19], 0 offen nt lds
    s_add_u32 m0, s54, 62400
    s_nop 0
    buffer_load_dwordx4 v158, s[16:19], 0 offen nt lds
    s_mov_b32 exec_hi, -1
    ds_read_b128 v[24:27], v148 offset:32000
    ds_read_b128 v[28:31], v149 offset:34800
    ds_read_b64_tr_b16 v[56:57], v150 offset:32064
    ds_read_b64_tr_b16 v[58:59], v152 offset:34864
    ds_read_b64_tr_b16 v[60:61], v151 offset:32080
    ds_read_b64_tr_b16 v[62:63], v153 offset:34880
    s_mov_b64 exec, s[44:45]
    ds_read_b128 v[144:147], v154 offset:0
    s_mov_b64 exec, -1
    s_mov_b64 exec, s[46:47]
    s_setprio 1
    v_cvt_pk_bf16_f32 v88, v104, v105
    s_mov_b64 exec, s[50:51]
    v_cvt_pk_bf16_f32 v90, v104, v105
    v_mov_b64 v[112:113], v[116:117]
    s_mov_b64 exec, s[48:49]
    v_cvt_pk_bf16_f32 v89, v106, v107
    s_mov_b64 exec, s[8:9]
    v_cvt_pk_bf16_f32 v91, v106, v107
    v_mov_b64 v[114:115], v[118:119]
    s_mov_b64 exec, -1
    v_exp_f32 v112, v112
    s_setprio 3
    v_mfma_f32_16x16x32_bf16 v[136:139], v[40:43], v[88:91], v[136:139]
    s_setprio 1
    v_exp_f32 v113, v113
    s_setprio 3
    v_mfma_f32_16x16x32_bf16 v[140:143], v[44:47], v[88:91], v[140:143]
    s_setprio 1
    v_exp_f32 v114, v114
    s_setprio 3
    s_waitcnt lgkmcnt(6)
    v_mfma_f32_16x16x32_bf16 v[120:123], v[24:27], v[164:167], v[84:87]
    s_setprio 1
    v_exp_f32 v115, v115
    s_setprio 3
    s_waitcnt lgkmcnt(5)
    v_mfma_f32_16x16x32_bf16 v[124:127], v[28:31], v[164:167], v[84:87]
    s_waitcnt lgkmcnt(0)
    v_mfma_f32_16x16x32_bf16 v[104:107], v[8:11], v[144:147], v[72:75]
    s_mov_b64 exec, s[46:47]
    s_setprio 1
    v_cvt_pk_bf16_f32 v92, v112, v113
    s_setprio 3
    v_mfma_f32_16x16x32_bf16 v[108:111], v[12:15], v[144:147], v[72:75]
    s_mov_b64 exec, s[50:51]
    s_setprio 1
    v_cvt_pk_bf16_f32 v94, v112, v113
    v_mov_b64 v[120:121], v[124:125]
    s_mov_b64 exec, s[48:49]
    v_cvt_pk_bf16_f32 v93, v114, v115
    s_mov_b64 exec, s[8:9]
    v_cvt_pk_bf16_f32 v95, v114, v115
    v_mov_b64 v[122:123], v[126:127]
    s_mov_b64 exec, -1
    v_exp_f32 v120, v120
    s_setprio 3
    v_mfma_f32_16x16x32_bf16 v[136:139], v[48:51], v[92:95], v[136:139]
    s_setprio 1
    v_exp_f32 v121, v121
    s_setprio 3
    v_mfma_f32_16x16x32_bf16 v[140:143], v[52:55], v[92:95], v[140:143]
    s_setprio 1
    v_exp_f32 v122, v122
    s_setprio 3
    v_mfma_f32_16x16x32_bf16 v[112:115], v[16:19], v[144:147], v[76:79]
    s_setprio 1
    v_exp_f32 v123, v123
    s_setprio 3
    v_mfma_f32_16x16x32_bf16 v[116:119], v[20:23], v[144:147], v[76:79]
    s_mov_b64 exec, s[46:47]
    s_setprio 1
    v_cvt_pk_bf16_f32 v96, v120, v121
    s_mov_b64 exec, s[50:51]
    v_cvt_pk_bf16_f32 v98, v120, v121
    v_mov_b64 v[104:105], v[108:109]
    s_mov_b64 exec, s[48:49]
    v_cvt_pk_bf16_f32 v97, v122, v123
    s_mov_b64 exec, s[8:9]
    v_cvt_pk_bf16_f32 v99, v122, v123
    v_mov_b64 v[106:107], v[110:111]
    s_mov_b64 exec, -1
    v_exp_f32 v104, v104
    s_setprio 3
    v_mfma_f32_16x16x32_bf16 v[136:139], v[56:59], v[96:99], v[136:139]
    s_setprio 1
    v_exp_f32 v105, v105
    s_setprio 3
    v_mfma_f32_16x16x32_bf16 v[140:143], v[60:63], v[96:99], v[140:143]
    s_setprio 1
    v_exp_f32 v106, v106
    s_setprio 3
    v_mfma_f32_16x16x32_bf16 v[120:123], v[24:27], v[144:147], v[80:83]
    s_setprio 1
    v_exp_f32 v107, v107
    s_setprio 3
    v_mfma_f32_16x16x32_bf16 v[124:127], v[28:31], v[144:147], v[80:83]
    s_mov_b64 exec, s[46:47]
    s_setprio 1
    v_cvt_pk_bf16_f32 v88, v104, v105
    s_mov_b64 exec, s[50:51]
    v_cvt_pk_bf16_f32 v90, v104, v105
    v_mov_b64 v[112:113], v[116:117]
    s_mov_b64 exec, s[48:49]
    v_cvt_pk_bf16_f32 v89, v106, v107
    s_mov_b64 exec, s[8:9]
    v_cvt_pk_bf16_f32 v91, v106, v107
    v_mov_b64 v[114:115], v[118:119]
    s_mov_b64 exec, -1
    v_permlane32_swap_b32 v140, v142
    s_setprio 0
    v_permlane32_swap_b32 v141, v143
    v_rcp_f32 v160, v142
    s_nop 0
    v_max3_f32 v159, v159, v142, v160
    v_mul_f32 v136, v136, v160
    v_mul_f32 v137, v137, v160
    v_mul_f32 v138, v138, v160
    v_mul_f32 v139, v139, v160
    v_cvt_pk_bf16_f32 v136, v136, v137
    v_cvt_pk_bf16_f32 v137, v138, v139
    v_mul_f32 v140, v140, v160
    v_mul_f32 v141, v141, v160
    ds_write_b64 v155, v[136:137] offset:0
    v_cvt_pk_bf16_f32 v140, v140, v141
    ds_write_b32 v156, v140 offset:512
    v_exp_f32 v112, v112
    s_setprio 2
    v_mfma_f32_16x16x32_bf16 v[136:139], v[40:43], v[88:91], 0
    s_setprio 0
    v_exp_f32 v113, v113
    s_setprio 2
    v_mfma_f32_16x16x32_bf16 v[140:143], v[44:47], v[88:91], 0
    s_setprio 0
    v_exp_f32 v114, v114
    v_exp_f32 v115, v115
    s_waitcnt lgkmcnt(0)
    s_barrier
    ds_read_b128 v[32:35], v148 offset:48000
    ds_read_b128 v[36:39], v149 offset:50800
    ds_read_b64_tr_b16 v[64:65], v150 offset:48064
    ds_read_b64_tr_b16 v[66:67], v152 offset:50864
    ds_read_b64_tr_b16 v[68:69], v151 offset:48080
    ds_read_b64_tr_b16 v[70:71], v153 offset:50880
    s_mov_b64 exec, s[44:45]
    ds_read_b128 v[164:167], v154 offset:6144
    s_mov_b64 exec, -1
    s_mov_b64 exec, s[46:47]
    s_setprio 1
    v_cvt_pk_bf16_f32 v92, v112, v113
    s_mov_b64 exec, s[50:51]
    v_cvt_pk_bf16_f32 v94, v112, v113
    v_mov_b64 v[120:121], v[124:125]
    s_mov_b64 exec, s[48:49]
    v_cvt_pk_bf16_f32 v93, v114, v115
    s_mov_b64 exec, s[8:9]
    v_cvt_pk_bf16_f32 v95, v114, v115
    v_mov_b64 v[122:123], v[126:127]
    s_mov_b64 exec, -1
    v_exp_f32 v120, v120
    s_setprio 3
    v_mfma_f32_16x16x32_bf16 v[136:139], v[48:51], v[92:95], v[136:139]
    s_setprio 1
    v_exp_f32 v121, v121
    s_setprio 3
    v_mfma_f32_16x16x32_bf16 v[140:143], v[52:55], v[92:95], v[140:143]
    s_setprio 1
    v_exp_f32 v122, v122
    s_setprio 3
    s_waitcnt lgkmcnt(6)
    v_mfma_f32_16x16x32_bf16 v[128:131], v[32:35], v[144:147], v[84:87]
    s_setprio 1
    v_exp_f32 v123, v123
    s_setprio 3
    s_waitcnt lgkmcnt(5)
    v_mfma_f32_16x16x32_bf16 v[132:135], v[36:39], v[144:147], v[84:87]
    s_waitcnt lgkmcnt(0)
    v_mfma_f32_16x16x32_bf16 v[112:115], v[16:19], v[164:167], v[72:75]
    s_mov_b64 exec, s[46:47]
    s_setprio 1
    v_cvt_pk_bf16_f32 v96, v120, v121
    s_setprio 3
    v_mfma_f32_16x16x32_bf16 v[116:119], v[20:23], v[164:167], v[72:75]
    s_mov_b64 exec, s[50:51]
    s_setprio 1
    v_cvt_pk_bf16_f32 v98, v120, v121
    v_mov_b64 v[128:129], v[132:133]
    s_mov_b64 exec, s[48:49]
    v_cvt_pk_bf16_f32 v97, v122, v123
    s_mov_b64 exec, s[8:9]
    v_cvt_pk_bf16_f32 v99, v122, v123
    v_mov_b64 v[130:131], v[134:135]
    s_mov_b64 exec, -1
    v_exp_f32 v128, v128
    s_setprio 3
    v_mfma_f32_16x16x32_bf16 v[136:139], v[56:59], v[96:99], v[136:139]
    s_setprio 1
    v_exp_f32 v129, v129
    s_setprio 3
    v_mfma_f32_16x16x32_bf16 v[140:143], v[60:63], v[96:99], v[140:143]
    s_setprio 1
    v_exp_f32 v130, v130
    s_setprio 3
    v_mfma_f32_16x16x32_bf16 v[120:123], v[24:27], v[164:167], v[76:79]
    s_setprio 1
    v_exp_f32 v131, v131
    s_setprio 3
    v_mfma_f32_16x16x32_bf16 v[124:127], v[28:31], v[164:167], v[76:79]
    s_mov_b64 exec, s[46:47]
    s_setprio 1
    v_cvt_pk_bf16_f32 v100, v128, v129
    s_mov_b64 exec, s[50:51]
    v_cvt_pk_bf16_f32 v102, v128, v129
    v_mov_b64 v[112:113], v[116:117]
    s_mov_b64 exec, s[48:49]
    v_cvt_pk_bf16_f32 v101, v130, v131
    s_mov_b64 exec, s[8:9]
    v_cvt_pk_bf16_f32 v103, v130, v131
    v_mov_b64 v[114:115], v[118:119]
    s_mov_b64 exec, -1
    v_exp_f32 v112, v112
    s_setprio 3
    v_mfma_f32_16x16x32_bf16 v[136:139], v[64:67], v[100:103], v[136:139]
    s_setprio 1
    v_exp_f32 v113, v113
    s_setprio 3
    v_mfma_f32_16x16x32_bf16 v[140:143], v[68:71], v[100:103], v[140:143]
    s_setprio 1
    v_exp_f32 v114, v114
    s_setprio 3
    v_mfma_f32_16x16x32_bf16 v[128:131], v[32:35], v[164:167], v[80:83]
    s_setprio 1
    v_exp_f32 v115, v115
    s_setprio 3
    v_mfma_f32_16x16x32_bf16 v[132:135], v[36:39], v[164:167], v[80:83]
    s_mov_b64 exec, s[46:47]
    s_setprio 1
    v_cvt_pk_bf16_f32 v92, v112, v113
    s_mov_b64 exec, s[50:51]
    v_cvt_pk_bf16_f32 v94, v112, v113
    v_mov_b64 v[120:121], v[124:125]
    s_mov_b64 exec, s[48:49]
    v_cvt_pk_bf16_f32 v93, v114, v115
    s_mov_b64 exec, s[8:9]
    v_cvt_pk_bf16_f32 v95, v114, v115
    v_mov_b64 v[122:123], v[126:127]
    s_mov_b64 exec, -1
    v_permlane32_swap_b32 v140, v142
    s_setprio 0
    v_permlane32_swap_b32 v141, v143
    v_rcp_f32 v160, v142
    s_nop 0
    v_max3_f32 v159, v159, v142, v160
    v_mul_f32 v136, v136, v160
    v_mul_f32 v137, v137, v160
    v_mul_f32 v138, v138, v160
    v_mul_f32 v139, v139, v160
    v_cvt_pk_bf16_f32 v136, v136, v137
    v_cvt_pk_bf16_f32 v137, v138, v139
    v_mul_f32 v140, v140, v160
    v_mul_f32 v141, v141, v160
    ds_write_b64 v155, v[136:137] offset:6144
    v_cvt_pk_bf16_f32 v140, v140, v141
    ds_write_b32 v156, v140 offset:6656
    v_exp_f32 v120, v120
    s_setprio 2
    v_mfma_f32_16x16x32_bf16 v[136:139], v[48:51], v[92:95], 0
    s_setprio 0
    v_exp_f32 v121, v121
    s_setprio 2
    v_mfma_f32_16x16x32_bf16 v[140:143], v[52:55], v[92:95], 0
    s_setprio 0
    v_exp_f32 v122, v122
    v_exp_f32 v123, v123
    s_waitcnt vmcnt(0) lgkmcnt(0)
    s_barrier
    ds_read_b128 v[8:11], v148 offset:0
    ds_read_b128 v[12:15], v149 offset:2800
    ds_read_b64_tr_b16 v[40:41], v150 offset:64
    ds_read_b64_tr_b16 v[42:43], v152 offset:2864
    ds_read_b64_tr_b16 v[44:45], v151 offset:80
    ds_read_b64_tr_b16 v[46:47], v153 offset:2880
    s_mov_b64 exec, s[44:45]
    ds_read_b128 v[144:147], v154 offset:12288
    s_mov_b64 exec, -1
    s_mov_b64 exec, s[46:47]
    s_setprio 1
    v_cvt_pk_bf16_f32 v96, v120, v121
    s_mov_b64 exec, s[50:51]
    v_cvt_pk_bf16_f32 v98, v120, v121
    v_mov_b64 v[128:129], v[132:133]
    s_mov_b64 exec, s[48:49]
    v_cvt_pk_bf16_f32 v97, v122, v123
    s_mov_b64 exec, s[8:9]
    v_cvt_pk_bf16_f32 v99, v122, v123
    v_mov_b64 v[130:131], v[134:135]
    s_mov_b64 exec, -1
    v_exp_f32 v128, v128
    s_setprio 3
    v_mfma_f32_16x16x32_bf16 v[136:139], v[56:59], v[96:99], v[136:139]
    s_setprio 1
    v_exp_f32 v129, v129
    s_setprio 3
    v_mfma_f32_16x16x32_bf16 v[140:143], v[60:63], v[96:99], v[140:143]
    s_setprio 1
    v_exp_f32 v130, v130
    s_setprio 3
    s_waitcnt lgkmcnt(6)
    v_mfma_f32_16x16x32_bf16 v[104:107], v[8:11], v[164:167], v[84:87]
    s_setprio 1
    v_exp_f32 v131, v131
    s_setprio 3
    s_waitcnt lgkmcnt(5)
    v_mfma_f32_16x16x32_bf16 v[108:111], v[12:15], v[164:167], v[84:87]
    s_waitcnt lgkmcnt(0)
    v_mfma_f32_16x16x32_bf16 v[120:123], v[24:27], v[144:147], v[72:75]
    s_mov_b64 exec, s[46:47]
    s_setprio 1
    v_cvt_pk_bf16_f32 v100, v128, v129
    s_setprio 3
    v_mfma_f32_16x16x32_bf16 v[124:127], v[28:31], v[144:147], v[72:75]
    s_mov_b64 exec, s[50:51]
    s_setprio 1
    v_cvt_pk_bf16_f32 v102, v128, v129
    v_mov_b64 v[104:105], v[108:109]
    s_mov_b64 exec, s[48:49]
    v_cvt_pk_bf16_f32 v101, v130, v131
    s_mov_b64 exec, s[8:9]
    v_cvt_pk_bf16_f32 v103, v130, v131
    v_mov_b64 v[106:107], v[110:111]
    s_mov_b64 exec, -1
    v_exp_f32 v104, v104
    s_setprio 3
    v_mfma_f32_16x16x32_bf16 v[136:139], v[64:67], v[100:103], v[136:139]
    s_setprio 1
    v_exp_f32 v105, v105
    s_setprio 3
    v_mfma_f32_16x16x32_bf16 v[140:143], v[68:71], v[100:103], v[140:143]
    s_setprio 1
    v_exp_f32 v106, v106
    s_setprio 3
    v_mfma_f32_16x16x32_bf16 v[128:131], v[32:35], v[144:147], v[76:79]
    s_setprio 1
    v_exp_f32 v107, v107
    s_setprio 3
    v_mfma_f32_16x16x32_bf16 v[132:135], v[36:39], v[144:147], v[76:79]
    s_mov_b64 exec, s[46:47]
    s_setprio 1
    v_cvt_pk_bf16_f32 v88, v104, v105
    s_mov_b64 exec, s[50:51]
    v_cvt_pk_bf16_f32 v90, v104, v105
    v_mov_b64 v[120:121], v[124:125]
    s_mov_b64 exec, s[48:49]
    v_cvt_pk_bf16_f32 v89, v106, v107
    s_mov_b64 exec, s[8:9]
    v_cvt_pk_bf16_f32 v91, v106, v107
    v_mov_b64 v[122:123], v[126:127]
    s_mov_b64 exec, -1
    v_exp_f32 v120, v120
    s_setprio 3
    v_mfma_f32_16x16x32_bf16 v[136:139], v[40:43], v[88:91], v[136:139]
    s_setprio 1
    v_exp_f32 v121, v121
    s_setprio 3
    v_mfma_f32_16x16x32_bf16 v[140:143], v[44:47], v[88:91], v[140:143]
    s_setprio 1
    v_exp_f32 v122, v122
    s_setprio 3
    v_mfma_f32_16x16x32_bf16 v[104:107], v[8:11], v[144:147], v[80:83]
    s_setprio 1
    v_exp_f32 v123, v123
    s_setprio 3
    v_mfma_f32_16x16x32_bf16 v[108:111], v[12:15], v[144:147], v[80:83]
    s_mov_b64 exec, s[46:47]
    s_setprio 1
    v_cvt_pk_bf16_f32 v96, v120, v121
    s_mov_b64 exec, s[50:51]
    v_cvt_pk_bf16_f32 v98, v120, v121
    v_mov_b64 v[128:129], v[132:133]
    s_mov_b64 exec, s[48:49]
    v_cvt_pk_bf16_f32 v97, v122, v123
    s_mov_b64 exec, s[8:9]
    v_cvt_pk_bf16_f32 v99, v122, v123
    v_mov_b64 v[130:131], v[134:135]
    s_mov_b64 exec, -1
    v_permlane32_swap_b32 v140, v142
    s_setprio 0
    v_permlane32_swap_b32 v141, v143
    v_rcp_f32 v160, v142
    s_nop 0
    v_max3_f32 v159, v159, v142, v160
    v_mul_f32 v136, v136, v160
    v_mul_f32 v137, v137, v160
    v_mul_f32 v138, v138, v160
    v_mul_f32 v139, v139, v160
    v_cvt_pk_bf16_f32 v136, v136, v137
    v_cvt_pk_bf16_f32 v137, v138, v139
    v_mul_f32 v140, v140, v160
    v_mul_f32 v141, v141, v160
    ds_write_b64 v155, v[136:137] offset:12288
    v_cvt_pk_bf16_f32 v140, v140, v141
    ds_write_b32 v156, v140 offset:12800
    v_exp_f32 v128, v128
    s_setprio 2
    v_mfma_f32_16x16x32_bf16 v[136:139], v[56:59], v[96:99], 0
    s_setprio 0
    v_exp_f32 v129, v129
    s_setprio 2
    v_mfma_f32_16x16x32_bf16 v[140:143], v[60:63], v[96:99], 0
    s_setprio 0
    v_exp_f32 v130, v130
    v_exp_f32 v131, v131
    s_waitcnt lgkmcnt(0)
    s_barrier
    ds_read_b128 v[16:19], v148 offset:16000
    ds_read_b128 v[20:23], v149 offset:18800
    ds_read_b64_tr_b16 v[48:49], v150 offset:16064
    ds_read_b64_tr_b16 v[50:51], v152 offset:18864
    ds_read_b64_tr_b16 v[52:53], v151 offset:16080
    ds_read_b64_tr_b16 v[54:55], v153 offset:18880
    s_mov_b64 exec, s[44:45]
    ds_read_b128 v[164:167], v154 offset:0
    s_mov_b64 exec, -1
    s_mov_b64 exec, s[46:47]
    s_setprio 1
    v_cvt_pk_bf16_f32 v100, v128, v129
    s_mov_b64 exec, s[50:51]
    v_cvt_pk_bf16_f32 v102, v128, v129
    v_mov_b64 v[104:105], v[108:109]
    s_mov_b64 exec, s[48:49]
    v_cvt_pk_bf16_f32 v101, v130, v131
    s_mov_b64 exec, s[8:9]
    v_cvt_pk_bf16_f32 v103, v130, v131
    v_mov_b64 v[106:107], v[110:111]
    s_mov_b64 exec, -1
    v_exp_f32 v104, v104
    s_setprio 3
    v_mfma_f32_16x16x32_bf16 v[136:139], v[64:67], v[100:103], v[136:139]
    s_setprio 1
    v_exp_f32 v105, v105
    s_setprio 3
    v_mfma_f32_16x16x32_bf16 v[140:143], v[68:71], v[100:103], v[140:143]
    s_setprio 1
    v_exp_f32 v106, v106
    s_setprio 3
    s_waitcnt lgkmcnt(6)
    v_mfma_f32_16x16x32_bf16 v[112:115], v[16:19], v[144:147], v[84:87]
    s_setprio 1
    v_exp_f32 v107, v107
    s_setprio 3
    s_waitcnt lgkmcnt(5)
    v_mfma_f32_16x16x32_bf16 v[116:119], v[20:23], v[144:147], v[84:87]
    s_cmp_eq_u32 s38, 0
    s_cbranch_scc1 L_e5g
    ds_read2_b32 v[72:73], v1 offset0:34 offset1:51
    ds_read2_b32 v[74:75], v2 offset0:35 offset1:52
    s_setprio 1
    v_mov_b32 v85, 0xff800000
    v_mov_b32 v87, 0xff800000
L_e5g:
    s_setprio 3
    s_waitcnt lgkmcnt(0)
    v_mfma_f32_16x16x32_bf16 v[128:131], v[32:35], v[164:167], v[72:75]
    s_mov_b64 exec, s[46:47]
    s_setprio 1
    v_cvt_pk_bf16_f32 v88, v104, v105
    s_setprio 3
    v_mfma_f32_16x16x32_bf16 v[132:135], v[36:39], v[164:167], v[72:75]
    s_mov_b64 exec, s[50:51]
    s_setprio 1
    v_cvt_pk_bf16_f32 v90, v104, v105
    v_mov_b64 v[112:113], v[116:117]
    s_mov_b64 exec, s[48:49]
    v_cvt_pk_bf16_f32 v89, v106, v107
    s_mov_b64 exec, s[8:9]
    v_cvt_pk_bf16_f32 v91, v106, v107
    v_mov_b64 v[114:115], v[118:119]
    s_mov_b64 exec, -1
    v_exp_f32 v112, v112
    s_setprio 3
    v_mfma_f32_16x16x32_bf16 v[136:139], v[40:43], v[88:91], v[136:139]
    s_setprio 1
    v_exp_f32 v113, v113
    s_setprio 3
    v_mfma_f32_16x16x32_bf16 v[140:143], v[44:47], v[88:91], v[140:143]
    s_setprio 1
    v_exp_f32 v114, v114
    s_setprio 3
    v_mfma_f32_16x16x32_bf16 v[104:107], v[8:11], v[164:167], v[76:79]
    s_setprio 1
    v_exp_f32 v115, v115
    s_setprio 3
    v_mfma_f32_16x16x32_bf16 v[108:111], v[12:15], v[164:167], v[76:79]
    s_mov_b64 exec, s[46:47]
    s_setprio 1
    v_cvt_pk_bf16_f32 v92, v112, v113
    s_mov_b64 exec, s[50:51]
    v_cvt_pk_bf16_f32 v94, v112, v113
    v_mov_b64 v[128:129], v[132:133]
    s_mov_b64 exec, s[48:49]
    v_cvt_pk_bf16_f32 v93, v114, v115
    s_mov_b64 exec, s[8:9]
    v_cvt_pk_bf16_f32 v95, v114, v115
    v_mov_b64 v[130:131], v[134:135]
    s_mov_b64 exec, -1
    v_exp_f32 v128, v128
    s_setprio 3
    v_mfma_f32_16x16x32_bf16 v[136:139], v[48:51], v[92:95], v[136:139]
    s_setprio 1
    v_exp_f32 v129, v129
    s_setprio 3
    v_mfma_f32_16x16x32_bf16 v[140:143], v[52:55], v[92:95], v[140:143]
    s_setprio 1
    v_exp_f32 v130, v130
    s_setprio 3
    v_mfma_f32_16x16x32_bf16 v[112:115], v[16:19], v[164:167], v[80:83]
    s_setprio 1
    v_exp_f32 v131, v131
    s_setprio 3
    v_mfma_f32_16x16x32_bf16 v[116:119], v[20:23], v[164:167], v[80:83]
    s_mov_b64 exec, s[46:47]
    s_setprio 1
    v_cvt_pk_bf16_f32 v100, v128, v129
    s_mov_b64 exec, s[50:51]
    v_cvt_pk_bf16_f32 v102, v128, v129
    v_mov_b64 v[104:105], v[108:109]
    s_mov_b64 exec, s[48:49]
    v_cvt_pk_bf16_f32 v101, v130, v131
    s_mov_b64 exec, s[8:9]
    v_cvt_pk_bf16_f32 v103, v130, v131
    v_mov_b64 v[106:107], v[110:111]
    s_mov_b64 exec, -1
    v_permlane32_swap_b32 v140, v142
    v_permlane32_swap_b32 v141, v143
    v_rcp_f32 v160, v142
    s_nop 0
    v_max3_f32 v159, v159, v142, v160
    v_mul_f32 v136, v136, v160
    v_mul_f32 v137, v137, v160
    v_mul_f32 v138, v138, v160
    v_mul_f32 v139, v139, v160
    v_cvt_pk_bf16_f32 v136, v136, v137
    v_cvt_pk_bf16_f32 v137, v138, v139
    s_setprio 0
    v_mul_f32 v140, v140, v160
    v_mul_f32 v141, v141, v160
    ds_write_b64 v155, v[136:137] offset:0
    v_cvt_pk_bf16_f32 v140, v140, v141
    ds_write_b32 v156, v140 offset:512
    v_exp_f32 v104, v104
    s_setprio 2
    v_mfma_f32_16x16x32_bf16 v[136:139], v[64:67], v[100:103], 0
    s_setprio 0
    v_exp_f32 v105, v105
    s_setprio 2
    v_mfma_f32_16x16x32_bf16 v[140:143], v[68:71], v[100:103], 0
    s_setprio 0
    v_exp_f32 v106, v106
    v_exp_f32 v107, v107
    s_waitcnt lgkmcnt(0)
    s_barrier
    ds_read_b128 v[24:27], v148 offset:32000
    ds_read_b128 v[28:31], v149 offset:34800
    ds_read_b64_tr_b16 v[56:57], v150 offset:32064
    ds_read_b64_tr_b16 v[58:59], v152 offset:34864
    ds_read_b64_tr_b16 v[60:61], v151 offset:32080
    ds_read_b64_tr_b16 v[62:63], v153 offset:34880
    s_mov_b64 exec, s[44:45]
    ds_read_b128 v[144:147], v154 offset:6144
    s_mov_b64 exec, -1
    s_mov_b64 exec, s[46:47]
    s_setprio 2
    v_cvt_pk_bf16_f32 v88, v104, v105
    s_mov_b64 exec, s[50:51]
    v_cvt_pk_bf16_f32 v90, v104, v105
    v_mov_b64 v[112:113], v[116:117]
    s_mov_b64 exec, s[48:49]
    v_cvt_pk_bf16_f32 v89, v106, v107
    s_mov_b64 exec, s[8:9]
    v_cvt_pk_bf16_f32 v91, v106, v107
    v_mov_b64 v[114:115], v[118:119]
    s_mov_b64 exec, -1
    v_exp_f32 v112, v112
    v_mfma_f32_16x16x32_bf16 v[136:139], v[40:43], v[88:91], v[136:139]
    v_exp_f32 v113, v113
    v_mfma_f32_16x16x32_bf16 v[140:143], v[44:47], v[88:91], v[140:143]
    v_exp_f32 v114, v114
    s_waitcnt lgkmcnt(6)
    v_mfma_f32_16x16x32_bf16 v[120:123], v[24:27], v[164:167], v[84:87]
    v_exp_f32 v115, v115
    s_waitcnt lgkmcnt(5)
    v_mfma_f32_16x16x32_bf16 v[124:127], v[28:31], v[164:167], v[84:87]
    s_cmp_eq_u32 s38, 0
    s_cbranch_scc1 L_e6g
    ds_read2_b32 v[84:85], v1 offset0:0 offset1:17
    ds_read2_b32 v[86:87], v2 offset0:1 offset1:18
    v_mov_b32 v81, 0xff800000
    v_mov_b32 v83, 0xff800000
L_e6g:
    s_cmp_lg_u32 s38, 0
    s_cbranch_scc1 L_s9g
    ds_read_b128 v[32:35], v148 offset:48000
    ds_read_b128 v[36:39], v149 offset:50800
    ds_read_b64_tr_b16 v[64:65], v150 offset:48064
    ds_read_b64_tr_b16 v[66:67], v152 offset:50864
    ds_read_b64_tr_b16 v[68:69], v151 offset:48080
    ds_read_b64_tr_b16 v[70:71], v153 offset:50880
L_s9g:
    s_waitcnt lgkmcnt(0)
    v_mfma_f32_16x16x32_bf16 v[104:107], v[8:11], v[144:147], v[72:75]
    s_mov_b64 exec, s[46:47]
    v_cvt_pk_bf16_f32 v92, v112, v113
    v_mfma_f32_16x16x32_bf16 v[108:111], v[12:15], v[144:147], v[72:75]
    s_mov_b64 exec, s[50:51]
    v_cvt_pk_bf16_f32 v94, v112, v113
    v_mov_b64 v[120:121], v[124:125]
    s_mov_b64 exec, s[48:49]
    v_cvt_pk_bf16_f32 v93, v114, v115
    s_mov_b64 exec, s[8:9]
    v_cvt_pk_bf16_f32 v95, v114, v115
    v_mov_b64 v[122:123], v[126:127]
    s_mov_b64 exec, -1
    v_exp_f32 v120, v120
    v_mfma_f32_16x16x32_bf16 v[136:139], v[48:51], v[92:95], v[136:139]
    v_exp_f32 v121, v121
    v_mfma_f32_16x16x32_bf16 v[140:143], v[52:55], v[92:95], v[140:143]
    v_exp_f32 v122, v122
    v_mfma_f32_16x16x32_bf16 v[112:115], v[16:19], v[144:147], v[76:79]
    v_exp_f32 v123, v123
    v_mfma_f32_16x16x32_bf16 v[116:119], v[20:23], v[144:147], v[76:79]
    s_mov_b64 exec, s[46:47]
    v_cvt_pk_bf16_f32 v96, v120, v121
    s_mov_b64 exec, s[50:51]
    v_cvt_pk_bf16_f32 v98, v120, v121
    v_mov_b64 v[104:105], v[108:109]
    s_mov_b64 exec, s[48:49]
    v_cvt_pk_bf16_f32 v97, v122, v123
    s_mov_b64 exec, s[8:9]
    v_cvt_pk_bf16_f32 v99, v122, v123
    v_mov_b64 v[106:107], v[110:111]
    s_mov_b64 exec, -1
    v_exp_f32 v104, v104
    v_mfma_f32_16x16x32_bf16 v[136:139], v[56:59], v[96:99], v[136:139]
    v_exp_f32 v105, v105
    v_mfma_f32_16x16x32_bf16 v[140:143], v[60:63], v[96:99], v[140:143]
    v_exp_f32 v106, v106
    v_mfma_f32_16x16x32_bf16 v[120:123], v[24:27], v[144:147], v[80:83]
    v_exp_f32 v107, v107
    v_mfma_f32_16x16x32_bf16 v[124:127], v[28:31], v[144:147], v[80:83]
    s_mov_b64 exec, s[46:47]
    v_cvt_pk_bf16_f32 v88, v104, v105
    s_mov_b64 exec, s[50:51]
    v_cvt_pk_bf16_f32 v90, v104, v105
    s_waitcnt lgkmcnt(5)
    v_mfma_f32_16x16x32_bf16 v[128:131], v[32:35], v[144:147], v[84:87]
    v_mov_b64 v[112:113], v[116:117]
    s_mov_b64 exec, s[48:49]
    v_cvt_pk_bf16_f32 v89, v106, v107
    s_waitcnt lgkmcnt(4)
    v_mfma_f32_16x16x32_bf16 v[132:135], v[36:39], v[144:147], v[84:87]
    s_mov_b64 exec, s[8:9]
    v_cvt_pk_bf16_f32 v91, v106, v107
    v_mov_b64 v[114:115], v[118:119]
    s_mov_b64 exec, -1
    v_permlane32_swap_b32 v140, v142
    v_permlane32_swap_b32 v141, v143
    v_rcp_f32 v160, v142
    s_nop 0
    v_max3_f32 v159, v159, v142, v160
    v_mul_f32 v136, v136, v160
    v_mul_f32 v137, v137, v160
    v_mul_f32 v138, v138, v160
    v_mul_f32 v139, v139, v160
    v_cvt_pk_bf16_f32 v136, v136, v137
    v_cvt_pk_bf16_f32 v137, v138, v139
    v_mul_f32 v140, v140, v160
    v_mul_f32 v141, v141, v160
    ds_write_b64 v155, v[136:137] offset:6144
    v_cvt_pk_bf16_f32 v140, v140, v141
    ds_write_b32 v156, v140 offset:6656
    v_exp_f32 v112, v112
    v_mfma_f32_16x16x32_bf16 v[136:139], v[40:43], v[88:91], 0
    v_exp_f32 v113, v113
    v_mfma_f32_16x16x32_bf16 v[140:143], v[44:47], v[88:91], 0
    v_exp_f32 v114, v114
    v_exp_f32 v115, v115
    s_mov_b64 exec, s[46:47]
    s_setprio 1
    v_cvt_pk_bf16_f32 v92, v112, v113
    s_mov_b64 exec, s[50:51]
    v_cvt_pk_bf16_f32 v94, v112, v113
    v_mov_b64 v[120:121], v[124:125]
    s_mov_b64 exec, s[48:49]
    v_cvt_pk_bf16_f32 v93, v114, v115
    s_mov_b64 exec, s[8:9]
    v_cvt_pk_bf16_f32 v95, v114, v115
    v_mov_b64 v[122:123], v[126:127]
    s_mov_b64 exec, -1
    v_exp_f32 v120, v120
    v_mfma_f32_16x16x32_bf16 v[136:139], v[48:51], v[92:95], v[136:139]
    v_exp_f32 v121, v121
    v_mfma_f32_16x16x32_bf16 v[140:143], v[52:55], v[92:95], v[140:143]
    v_exp_f32 v122, v122
    v_exp_f32 v123, v123
    s_mov_b64 exec, s[46:47]
    v_cvt_pk_bf16_f32 v96, v120, v121
    s_mov_b64 exec, s[50:51]
    v_cvt_pk_bf16_f32 v98, v120, v121
    v_mov_b64 v[128:129], v[132:133]
    s_mov_b64 exec, s[48:49]
    v_cvt_pk_bf16_f32 v97, v122, v123
    s_mov_b64 exec, s[8:9]
    v_cvt_pk_bf16_f32 v99, v122, v123
    v_mov_b64 v[130:131], v[134:135]
    s_mov_b64 exec, -1
    v_mfma_f32_16x16x32_bf16 v[136:139], v[56:59], v[96:99], v[136:139]
    v_mfma_f32_16x16x32_bf16 v[140:143], v[60:63], v[96:99], v[140:143]
    s_waitcnt lgkmcnt(0)
    s_barrier
    v_exp_f32 v128, v128
    v_exp_f32 v129, v129
    v_exp_f32 v130, v130
    v_exp_f32 v131, v131
    s_mov_b64 exec, s[46:47]
    v_cvt_pk_bf16_f32 v100, v128, v129
    s_mov_b64 exec, s[50:51]
    v_cvt_pk_bf16_f32 v102, v128, v129
    s_mov_b64 exec, s[48:49]
    v_cvt_pk_bf16_f32 v101, v130, v131
    s_mov_b64 exec, s[8:9]
    v_cvt_pk_bf16_f32 v103, v130, v131
    s_mov_b64 exec, -1
    s_setprio 3
    v_mfma_f32_16x16x32_bf16 v[136:139], v[64:67], v[100:103], v[136:139]
    v_mfma_f32_16x16x32_bf16 v[140:143], v[68:71], v[100:103], v[140:143]
    s_setprio 1
    s_nop 6
    v_permlane32_swap_b32 v140, v142
    v_permlane32_swap_b32 v141, v143
    v_rcp_f32 v160, v142
    s_nop 0
    v_max3_f32 v159, v159, v142, v160
    v_mul_f32 v136, v136, v160
    v_mul_f32 v137, v137, v160
    v_mul_f32 v138, v138, v160
    v_mul_f32 v139, v139, v160
    v_cvt_pk_bf16_f32 v136, v136, v137
    s_setprio 0
    v_cvt_pk_bf16_f32 v137, v138, v139
    v_mul_f32 v140, v140, v160
    v_mul_f32 v141, v141, v160
    ds_write_b64 v155, v[136:137] offset:12288
    v_cvt_pk_bf16_f32 v140, v140, v141
    ds_write_b32 v156, v140 offset:12800
    s_waitcnt lgkmcnt(0)
    s_barrier
    v_mov_b32 v161, 0x5d800000
    v_cmp_gt_f32 vcc, v159, v161
    v_mov_b32 v162, 0
    s_and_b64 exec, vcc, exec
    ds_write_b32 v162, v161
    s_mov_b64 exec, -1
    s_branch L_fin
L_prod:
    s_and_b32 s53, s3, 1
    v_mul_u32_u24 v131, 68, v120
    s_mul_i32 s62, s53, 3072
    v_lshl_add_u32 v131, v121, 2, v131
    s_add_u32 s62, s62, 81408
    v_lshl_add_u32 v130, v121, 4, s62
    s_lshl_b32 s62, s3, 10
    v_add_u32 v131, s62, v131
    s_cmp_ge_u32 s3, 2
    s_cbranch_scc1 L_prodO
    v_mad_u32_u24 v128, v125, 3, 0
    v_bitop3_b32 v128, v128, v123, 2 bitop3:0x78
    v_lshl_add_u32 v157, v128, 4, v122
    v_mad_u32_u24 v128, v125, 3, 1
    v_bitop3_b32 v128, v128, v123, 2 bitop3:0x78
    v_lshl_add_u32 v158, v128, 4, v122
    v_mad_u32_u24 v128, v125, 3, 2
    v_bitop3_b32 v128, v128, v123, 2 bitop3:0x78
    v_lshl_add_u32 v159, v128, 4, v122
    v_mul_u32_u24 v125, 768, v120
    v_add_u32 v4, v125, v130
    v_lshrrev_b32 v125, 3, v121
    v_and_b32 v126, 7, v121
    s_mul_i32 s62, s53, 7
    v_min_u32 v126, 6, v126
    s_add_u32 s62, s62, 63
    v_mad_u32_u24 v125, v125, 20, v126
    s_mov_b32 s56, 0x3e96c740
    v_add_u32 v125, s62, v125
    v_lshrrev_b32 v126, 2, v125
    v_mul_u32_u24 v125, 12, v125
    v_bitop3_b32 v126, v120, v126, 2 bitop3:0x78
    v_add_lshl_u32 v3, v125, v126, 4
    v_add_u32 v3, 4608, v3
    v_xor_b32 v2, 32, v3
    s_waitcnt vmcnt(2)
    v_lshlrev_b32 v132, 16, v132
    s_waitcnt vmcnt(1)
    v_lshlrev_b32 v133, 16, v133
    s_waitcnt vmcnt(0)
    v_lshlrev_b32 v134, 16, v134
    s_cmp_eq_u32 s37, 0
    s_cbranch_scc1 L_nfq
    v_swap_b32 v132, v134
L_nfq:
    v_mul_f32 v132, 0x3fb8aa3b, v132
    v_mul_f32 v133, 0x3fb8aa3b, v133
    v_mul_f32 v134, 0x3fb8aa3b, v134
    ds_write_b32 v131, v132 offset:512
    ds_write_b32 v131, v133 offset:784
    s_bfm_b64 exec, 16, 32
    v_mov_b32 v132, 0xff800000
    v_mov_b32 v134, 0xff800000
    s_mov_b32 exec_hi, -1
    ds_write_b32 v131, v132 offset:716
    s_mov_b32 exec_lo, -1
    ds_write_b32 v131, v133 offset:988
    ds_write_b32 v131, v134 offset:1260
    s_waitcnt lgkmcnt(0)
    s_barrier
    s_add_u32 m0, s59, 66048
    s_add_u32 s61, s59, 0
    buffer_load_dwordx4 v140, s[20:23], s61 offen offset:0 lds
    buffer_load_dwordx4 v140, s[20:23], s61 offen offset:1024 lds
    s_add_u32 m0, s59, 70144
    s_add_u32 s61, s59, 4096
    buffer_load_dwordx4 v142, s[20:23], s61 offen lds
    buffer_load_dwordx4 v141, s[20:23], s61 offen offset:1024 lds
    buffer_load_dwordx4 v141, s[20:23], s61 offen offset:2048 lds
    s_add_u32 m0, s59, 93696
    s_add_u32 s61, s59, 18432
    buffer_load_dwordx4 v140, s[20:23], s61 offen offset:0 lds
    buffer_load_dwordx4 v140, s[20:23], s61 offen offset:1024 lds
    s_add_u32 m0, s59, 97792
    s_add_u32 s61, s59, 22528
    buffer_load_dwordx4 v142, s[20:23], s61 offen lds
    buffer_load_dwordx4 v141, s[20:23], s61 offen offset:1024 lds
    buffer_load_dwordx4 v141, s[20:23], s61 offen offset:2048 lds
    s_waitcnt vmcnt(5) lgkmcnt(0)
    s_barrier
    s_add_u32 m0, s59, 112128
    s_add_u32 s61, s59, 36864
    buffer_load_dwordx4 v140, s[20:23], s61 offen offset:0 lds
    buffer_load_dwordx4 v140, s[20:23], s61 offen offset:1024 lds
    s_add_u32 m0, s59, 116224
    s_add_u32 s61, s59, 40960
    buffer_load_dwordx4 v142, s[20:23], s61 offen lds
    buffer_load_dwordx4 v141, s[20:23], s61 offen offset:1024 lds
    buffer_load_dwordx4 v141, s[20:23], s61 offen offset:2048 lds
    ds_read_b128 v[140:143], v3 offset:0
    ds_read_b128 v[144:147], v3 offset:64
    ds_read_b128 v[148:151], v3 offset:128
    ds_read_b64_tr_b16 v[44:45], v157 offset:0
    ds_read_b64_tr_b16 v[46:47], v157 offset:2304
    ds_read_b64_tr_b16 v[48:49], v157 offset:8
    ds_read_b64_tr_b16 v[50:51], v157 offset:2312
    ds_read_b64_tr_b16 v[52:53], v158 offset:0
    ds_read_b64_tr_b16 v[54:55], v158 offset:2304
    ds_read_b64_tr_b16 v[56:57], v158 offset:8
    ds_read_b64_tr_b16 v[58:59], v158 offset:2312
    ds_read_b64_tr_b16 v[60:61], v159 offset:8
    ds_read_b64_tr_b16 v[62:63], v159 offset:2312
    ds_read_b64_tr_b16 v[64:65], v159 offset:0
    ds_read_b64_tr_b16 v[66:67], v159 offset:2304
    s_waitcnt lgkmcnt(10)
    v_mfma_f32_16x16x32_bf16 v[116:119], v[44:47], v[140:143], 0
    s_waitcnt lgkmcnt(8)
    v_mfma_f32_16x16x32_bf16 v[120:123], v[48:51], v[140:143], 0
    s_waitcnt lgkmcnt(6)
    v_mfma_f32_16x16x32_bf16 v[124:127], v[52:55], v[140:143], 0
    s_waitcnt lgkmcnt(4)
    v_mfma_f32_16x16x32_bf16 v[128:131], v[56:59], v[140:143], 0
    s_waitcnt lgkmcnt(2)
    v_mfma_f32_16x16x32_bf16 v[132:135], v[60:63], v[140:143], 0
    s_waitcnt lgkmcnt(0)
    v_mfma_f32_16x16x32_bf16 v[136:139], v[64:67], v[140:143], 0
    ds_read_b64_tr_b16 v[8:9], v161 offset:0
    ds_read_b64_tr_b16 v[10:11], v161 offset:2304
    ds_read_b64_tr_b16 v[12:13], v162 offset:0
    ds_read_b64_tr_b16 v[14:15], v162 offset:2304
    ds_read_b64_tr_b16 v[16:17], v163 offset:0
    ds_read_b64_tr_b16 v[18:19], v163 offset:2304
    s_waitcnt vmcnt(0) lgkmcnt(0)
    s_barrier
    ds_read_b64_tr_b16 v[68:69], v157 offset:27648
    ds_read_b64_tr_b16 v[70:71], v157 offset:29952
    ds_read_b64_tr_b16 v[72:73], v157 offset:27656
    ds_read_b64_tr_b16 v[74:75], v157 offset:29960
    ds_read_b64_tr_b16 v[76:77], v158 offset:27648
    ds_read_b64_tr_b16 v[78:79], v158 offset:29952
    ds_read_b64_tr_b16 v[80:81], v158 offset:27656
    ds_read_b64_tr_b16 v[82:83], v158 offset:29960
    ds_read_b64_tr_b16 v[84:85], v159 offset:27656
    ds_read_b64_tr_b16 v[86:87], v159 offset:29960
    ds_read_b64_tr_b16 v[88:89], v159 offset:27648
    ds_read_b64_tr_b16 v[90:91], v159 offset:29952
    s_waitcnt lgkmcnt(10)
    v_mfma_f32_16x16x32_bf16 v[116:119], v[68:71], v[144:147], v[116:119]
    ds_read_b64_tr_b16 v[92:93], v157 offset:46080
    ds_read_b64_tr_b16 v[94:95], v157 offset:48384
    ds_read_b64_tr_b16 v[96:97], v157 offset:46088
    s_waitcnt lgkmcnt(11)
    v_mfma_f32_16x16x32_bf16 v[120:123], v[72:75], v[144:147], v[120:123]
    ds_read_b64_tr_b16 v[98:99], v157 offset:48392
    ds_read_b64_tr_b16 v[100:101], v158 offset:46080
    ds_read_b64_tr_b16 v[102:103], v158 offset:48384
    s_waitcnt lgkmcnt(12)
    v_mfma_f32_16x16x32_bf16 v[124:127], v[76:79], v[144:147], v[124:127]
    ds_read_b64_tr_b16 v[104:105], v158 offset:46088
    ds_read_b64_tr_b16 v[106:107], v158 offset:48392
    ds_read_b64_tr_b16 v[108:109], v159 offset:46088
    s_waitcnt lgkmcnt(13)
    v_mfma_f32_16x16x32_bf16 v[128:131], v[80:83], v[144:147], v[128:131]
    ds_read_b64_tr_b16 v[110:111], v159 offset:48392
    ds_read_b64_tr_b16 v[112:113], v159 offset:46080
    ds_read_b64_tr_b16 v[114:115], v159 offset:48384
    s_waitcnt lgkmcnt(14)
    v_mfma_f32_16x16x32_bf16 v[132:135], v[84:87], v[144:147], v[132:135]
    s_waitcnt lgkmcnt(12)
    v_mfma_f32_16x16x32_bf16 v[136:139], v[88:91], v[144:147], v[136:139]
    s_waitcnt lgkmcnt(10)
    v_mfma_f32_16x16x32_bf16 v[116:119], v[92:95], v[148:151], v[116:119]
    s_waitcnt lgkmcnt(8)
    v_mfma_f32_16x16x32_bf16 v[120:123], v[96:99], v[148:151], v[120:123]
    s_waitcnt lgkmcnt(6)
    v_mfma_f32_16x16x32_bf16 v[124:127], v[100:103], v[148:151], v[124:127]
    s_waitcnt lgkmcnt(4)
    v_mfma_f32_16x16x32_bf16 v[128:131], v[104:107], v[148:151], v[128:131]
    s_waitcnt lgkmcnt(2)
    v_mfma_f32_16x16x32_bf16 v[132:135], v[108:111], v[148:151], v[132:135]
    s_waitcnt lgkmcnt(0)
    v_mfma_f32_16x16x32_bf16 v[136:139], v[112:115], v[148:151], v[136:139]
    v_mul_f32 v116, s56, v116
    v_mul_f32 v117, s56, v117
    v_mul_f32 v118, s56, v118
    v_mul_f32 v119, s56, v119
    v_mul_f32 v120, s56, v120
    v_mul_f32 v121, s56, v121
    v_mul_f32 v122, s56, v122
    v_mul_f32 v123, s56, v123
    v_cvt_pk_bf16_f32 v116, v116, v117
    v_cvt_pk_bf16_f32 v117, v118, v119
    v_cvt_pk_bf16_f32 v118, v120, v121
    v_cvt_pk_bf16_f32 v119, v122, v123
    ds_write_b128 v4, v[116:119] offset:6144
    v_mul_f32 v124, s56, v124
    v_mul_f32 v125, s56, v125
    v_mul_f32 v126, s56, v126
    v_mul_f32 v127, s56, v127
    v_mul_f32 v128, s56, v128
    v_mul_f32 v129, s56, v129
    v_mul_f32 v130, s56, v130
    v_mul_f32 v131, s56, v131
    v_cvt_pk_bf16_f32 v124, v124, v125
    v_cvt_pk_bf16_f32 v125, v126, v127
    v_cvt_pk_bf16_f32 v126, v128, v129
    v_cvt_pk_bf16_f32 v127, v130, v131
    ds_write_b128 v4, v[124:127] offset:6400
    v_mul_f32 v132, s56, v132
    v_mul_f32 v133, s56, v133
    v_mul_f32 v134, s56, v134
    v_mul_f32 v135, s56, v135
    v_mul_f32 v136, s56, v136
    v_mul_f32 v137, s56, v137
    v_mul_f32 v138, s56, v138
    v_mul_f32 v139, s56, v139
    v_cvt_pk_bf16_f32 v132, v132, v133
    v_cvt_pk_bf16_f32 v133, v134, v135
    v_cvt_pk_bf16_f32 v134, v136, v137
    v_cvt_pk_bf16_f32 v135, v138, v139
    ds_write_b128 v4, v[132:135] offset:6656
    ds_read_b64_tr_b16 v[20:21], v161 offset:27648
    ds_read_b64_tr_b16 v[22:23], v161 offset:29952
    ds_read_b64_tr_b16 v[24:25], v162 offset:27648
    ds_read_b64_tr_b16 v[26:27], v162 offset:29952
    ds_read_b64_tr_b16 v[28:29], v163 offset:27648
    ds_read_b64_tr_b16 v[30:31], v163 offset:29952
    ds_read_b64_tr_b16 v[32:33], v161 offset:46080
    ds_read_b64_tr_b16 v[34:35], v161 offset:48384
    ds_read_b64_tr_b16 v[36:37], v162 offset:46080
    ds_read_b64_tr_b16 v[38:39], v162 offset:48384
    ds_read_b64_tr_b16 v[40:41], v163 offset:46080
    ds_read_b64_tr_b16 v[42:43], v163 offset:48384
    s_waitcnt lgkmcnt(0)
    s_barrier
    ds_read_b128 v[152:155], v2 offset:7680
    ds_read_b128 v[140:143], v2 offset:7744
    ds_read_b128 v[144:147], v2 offset:7808
    s_waitcnt lgkmcnt(2)
    v_mfma_f32_16x16x32_bf16 v[116:119], v[44:47], v[152:155], 0
    v_mfma_f32_16x16x32_bf16 v[120:123], v[48:51], v[152:155], 0
    v_mfma_f32_16x16x32_bf16 v[124:127], v[52:55], v[152:155], 0
    v_mfma_f32_16x16x32_bf16 v[128:131], v[56:59], v[152:155], 0
    v_mfma_f32_16x16x32_bf16 v[132:135], v[60:63], v[152:155], 0
    v_mfma_f32_16x16x32_bf16 v[136:139], v[64:67], v[152:155], 0
    s_waitcnt lgkmcnt(1)
    v_mfma_f32_16x16x32_bf16 v[116:119], v[68:71], v[140:143], v[116:119]
    v_mfma_f32_16x16x32_bf16 v[120:123], v[72:75], v[140:143], v[120:123]
    v_mfma_f32_16x16x32_bf16 v[124:127], v[76:79], v[140:143], v[124:127]
    v_mfma_f32_16x16x32_bf16 v[128:131], v[80:83], v[140:143], v[128:131]
    v_mfma_f32_16x16x32_bf16 v[132:135], v[84:87], v[140:143], v[132:135]
    v_mfma_f32_16x16x32_bf16 v[136:139], v[88:91], v[140:143], v[136:139]
    s_waitcnt lgkmcnt(0)
    v_mfma_f32_16x16x32_bf16 v[116:119], v[92:95], v[144:147], v[116:119]
    v_mfma_f32_16x16x32_bf16 v[120:123], v[96:99], v[144:147], v[120:123]
    v_mfma_f32_16x16x32_bf16 v[124:127], v[100:103], v[144:147], v[124:127]
    v_mfma_f32_16x16x32_bf16 v[128:131], v[104:107], v[144:147], v[128:131]
    v_mfma_f32_16x16x32_bf16 v[132:135], v[108:111], v[144:147], v[132:135]
    v_mfma_f32_16x16x32_bf16 v[136:139], v[112:115], v[144:147], v[136:139]
    s_nop 2
    v_mul_f32 v116, s56, v116
    v_mul_f32 v117, s56, v117
    v_mul_f32 v118, s56, v118
    v_mul_f32 v119, s56, v119
    v_mul_f32 v120, s56, v120
    v_mul_f32 v121, s56, v121
    v_mul_f32 v122, s56, v122
    v_mul_f32 v123, s56, v123
    v_cvt_pk_bf16_f32 v116, v116, v117
    v_cvt_pk_bf16_f32 v117, v118, v119
    v_cvt_pk_bf16_f32 v118, v120, v121
    v_cvt_pk_bf16_f32 v119, v122, v123
    ds_write_b128 v4, v[116:119] offset:12288
    v_mul_f32 v124, s56, v124
    v_mul_f32 v125, s56, v125
    v_mul_f32 v126, s56, v126
    v_mul_f32 v127, s56, v127
    v_mul_f32 v128, s56, v128
    v_mul_f32 v129, s56, v129
    v_mul_f32 v130, s56, v130
    v_mul_f32 v131, s56, v131
    v_cvt_pk_bf16_f32 v124, v124, v125
    v_cvt_pk_bf16_f32 v125, v126, v127
    v_cvt_pk_bf16_f32 v126, v128, v129
    v_cvt_pk_bf16_f32 v127, v130, v131
    ds_write_b128 v4, v[124:127] offset:12544
    v_mul_f32 v132, s56, v132
    v_mul_f32 v133, s56, v133
    v_mul_f32 v134, s56, v134
    v_mul_f32 v135, s56, v135
    v_mul_f32 v136, s56, v136
    v_mul_f32 v137, s56, v137
    v_mul_f32 v138, s56, v138
    v_mul_f32 v139, s56, v139
    v_cvt_pk_bf16_f32 v132, v132, v133
    v_cvt_pk_bf16_f32 v133, v134, v135
    v_cvt_pk_bf16_f32 v134, v136, v137
    v_cvt_pk_bf16_f32 v135, v138, v139
    ds_write_b128 v4, v[132:135] offset:12800
    s_waitcnt lgkmcnt(0)
    s_barrier
    ds_read_b128 v[148:151], v3 offset:15360
    ds_read_b128 v[152:155], v3 offset:15424
    ds_read_b128 v[140:143], v3 offset:15488
    ds_read_b128 v[144:147], v5 offset:30720
    s_waitcnt lgkmcnt(3)
    v_mfma_f32_16x16x32_bf16 v[116:119], v[44:47], v[148:151], 0
    v_mfma_f32_16x16x32_bf16 v[120:123], v[48:51], v[148:151], 0
    v_mfma_f32_16x16x32_bf16 v[124:127], v[52:55], v[148:151], 0
    v_mfma_f32_16x16x32_bf16 v[128:131], v[56:59], v[148:151], 0
    v_mfma_f32_16x16x32_bf16 v[132:135], v[60:63], v[148:151], 0
    v_mfma_f32_16x16x32_bf16 v[136:139], v[64:67], v[148:151], 0
    s_waitcnt lgkmcnt(2)
    v_mfma_f32_16x16x32_bf16 v[116:119], v[68:71], v[152:155], v[116:119]
    ds_read_b128 v[148:151], v5 offset:30784
    v_mfma_f32_16x16x32_bf16 v[120:123], v[72:75], v[152:155], v[120:123]
    v_mfma_f32_16x16x32_bf16 v[124:127], v[76:79], v[152:155], v[124:127]
    v_mfma_f32_16x16x32_bf16 v[128:131], v[80:83], v[152:155], v[128:131]
    v_mfma_f32_16x16x32_bf16 v[132:135], v[84:87], v[152:155], v[132:135]
    v_mfma_f32_16x16x32_bf16 v[136:139], v[88:91], v[152:155], v[136:139]
    s_waitcnt lgkmcnt(2)
    v_mfma_f32_16x16x32_bf16 v[116:119], v[92:95], v[140:143], v[116:119]
    ds_read_b128 v[152:155], v5 offset:30848
    v_mfma_f32_16x16x32_bf16 v[120:123], v[96:99], v[140:143], v[120:123]
    v_mfma_f32_16x16x32_bf16 v[124:127], v[100:103], v[140:143], v[124:127]
    v_mfma_f32_16x16x32_bf16 v[128:131], v[104:107], v[140:143], v[128:131]
    v_mfma_f32_16x16x32_bf16 v[132:135], v[108:111], v[140:143], v[132:135]
    v_mfma_f32_16x16x32_bf16 v[136:139], v[112:115], v[140:143], v[136:139]
    s_waitcnt lgkmcnt(2)
    v_mfma_f32_16x16x32_bf16 v[156:159], v[8:11], v[144:147], 0
    v_mul_f32 v116, s56, v116
    v_mul_f32 v117, s56, v117
    ds_read_b128 v[140:143], v5 offset:33792
    v_mfma_f32_16x16x32_bf16 v[160:163], v[12:15], v[144:147], 0
    v_mul_f32 v118, s56, v118
    v_mul_f32 v119, s56, v119
    v_mul_f32 v120, s56, v120
    v_mfma_f32_16x16x32_bf16 v[164:167], v[16:19], v[144:147], 0
    v_mul_f32 v121, s56, v121
    v_mul_f32 v122, s56, v122
    v_mul_f32 v123, s56, v123
    s_waitcnt lgkmcnt(2)
    v_mfma_f32_16x16x32_bf16 v[156:159], v[20:23], v[148:151], v[156:159]
    v_cvt_pk_bf16_f32 v116, v116, v117
    v_cvt_pk_bf16_f32 v117, v118, v119
    v_cvt_pk_bf16_f32 v118, v120, v121
    ds_read_b128 v[144:147], v5 offset:33856
    v_mfma_f32_16x16x32_bf16 v[160:163], v[24:27], v[148:151], v[160:163]
    v_cvt_pk_bf16_f32 v119, v122, v123
    ds_write_b128 v4, v[116:119] offset:0
    v_mul_f32 v124, s56, v124
    v_mfma_f32_16x16x32_bf16 v[164:167], v[28:31], v[148:151], v[164:167]
    v_mul_f32 v125, s56, v125
    v_mul_f32 v126, s56, v126
    v_mul_f32 v127, s56, v127
    s_waitcnt lgkmcnt(3)
    v_mfma_f32_16x16x32_bf16 v[156:159], v[32:35], v[152:155], v[156:159]
    v_mul_f32 v128, s56, v128
    v_mul_f32 v129, s56, v129
    v_mul_f32 v130, s56, v130
    ds_read_b128 v[148:151], v5 offset:33920
    v_mfma_f32_16x16x32_bf16 v[160:163], v[36:39], v[152:155], v[160:163]
    v_mul_f32 v131, s56, v131
    v_cvt_pk_bf16_f32 v124, v124, v125
    v_cvt_pk_bf16_f32 v125, v126, v127
    v_mfma_f32_16x16x32_bf16 v[164:167], v[40:43], v[152:155], v[164:167]
    v_cvt_pk_bf16_f32 v126, v128, v129
    v_cvt_pk_bf16_f32 v127, v130, v131
    ds_write_b128 v4, v[124:127] offset:256
    s_waitcnt lgkmcnt(4)
    v_mfma_f32_16x16x32_bf16 v[116:119], v[8:11], v[140:143], 0
    v_cvt_pk_bf16_f32 v156, v156, v157
    v_cvt_pk_bf16_f32 v157, v158, v159
    ds_read_b128 v[152:155], v5 offset:36864
    v_mfma_f32_16x16x32_bf16 v[120:123], v[12:15], v[140:143], 0
    v_cvt_pk_bf16_f32 v158, v160, v161
    v_cvt_pk_bf16_f32 v159, v162, v163
    v_mfma_f32_16x16x32_bf16 v[124:127], v[16:19], v[140:143], 0
    ds_write_b128 v6, v[156:159] offset:32000
    v_cvt_pk_bf16_f32 v164, v164, v165
    v_cvt_pk_bf16_f32 v165, v166, v167
    s_waitcnt lgkmcnt(5)
    v_mfma_f32_16x16x32_bf16 v[116:119], v[20:23], v[144:147], v[116:119]
    ds_write_b64 v7, v[164:165] offset:32064
    v_mul_f32 v132, s56, v132
    ds_read_b128 v[140:143], v5 offset:36928
    v_mfma_f32_16x16x32_bf16 v[120:123], v[24:27], v[144:147], v[120:123]
    v_mul_f32 v133, s56, v133
    v_mul_f32 v134, s56, v134
    v_mfma_f32_16x16x32_bf16 v[124:127], v[28:31], v[144:147], v[124:127]
    v_mul_f32 v135, s56, v135
    v_mul_f32 v136, s56, v136
    v_mul_f32 v137, s56, v137
    s_waitcnt lgkmcnt(5)
    v_mfma_f32_16x16x32_bf16 v[116:119], v[32:35], v[148:151], v[116:119]
    v_mul_f32 v138, s56, v138
    v_mul_f32 v139, s56, v139
    ds_read_b128 v[144:147], v5 offset:36992
    v_mfma_f32_16x16x32_bf16 v[120:123], v[36:39], v[148:151], v[120:123]
    v_cvt_pk_bf16_f32 v132, v132, v133
    v_cvt_pk_bf16_f32 v133, v134, v135
    v_mfma_f32_16x16x32_bf16 v[124:127], v[40:43], v[148:151], v[124:127]
    v_cvt_pk_bf16_f32 v134, v136, v137
    v_cvt_pk_bf16_f32 v135, v138, v139
    ds_write_b128 v4, v[132:135] offset:512
    s_waitcnt lgkmcnt(5)
    v_mfma_f32_16x16x32_bf16 v[156:159], v[8:11], v[152:155], 0
    ds_read_b128 v[148:151], v2 offset:23040
    v_mfma_f32_16x16x32_bf16 v[160:163], v[12:15], v[152:155], 0
    v_cvt_pk_bf16_f32 v116, v116, v117
    v_mfma_f32_16x16x32_bf16 v[164:167], v[16:19], v[152:155], 0
    v_cvt_pk_bf16_f32 v117, v118, v119
    s_waitcnt lgkmcnt(3)
    v_mfma_f32_16x16x32_bf16 v[156:159], v[20:23], v[140:143], v[156:159]
    v_cvt_pk_bf16_f32 v118, v120, v121
    ds_read_b128 v[152:155], v2 offset:23104
    v_mfma_f32_16x16x32_bf16 v[160:163], v[24:27], v[140:143], v[160:163]
    v_cvt_pk_bf16_f32 v119, v122, v123
    v_mfma_f32_16x16x32_bf16 v[164:167], v[28:31], v[140:143], v[164:167]
    ds_write_b128 v6, v[116:119] offset:38400
    s_waitcnt lgkmcnt(4)
    v_mfma_f32_16x16x32_bf16 v[156:159], v[32:35], v[144:147], v[156:159]
    v_cvt_pk_bf16_f32 v124, v124, v125
    ds_read_b128 v[140:143], v2 offset:23168
    v_mfma_f32_16x16x32_bf16 v[160:163], v[36:39], v[144:147], v[160:163]
    v_cvt_pk_bf16_f32 v125, v126, v127
    v_mfma_f32_16x16x32_bf16 v[164:167], v[40:43], v[144:147], v[164:167]
    ds_write_b64 v7, v[124:125] offset:38464
    ds_read_b128 v[144:147], v5 offset:39936
    s_nop 0
    v_cvt_pk_bf16_f32 v156, v156, v157
    v_cvt_pk_bf16_f32 v157, v158, v159
    s_nop 0
    v_cvt_pk_bf16_f32 v158, v160, v161
    v_cvt_pk_bf16_f32 v159, v162, v163
    ds_write_b128 v6, v[156:159] offset:44800
    v_cvt_pk_bf16_f32 v164, v164, v165
    v_cvt_pk_bf16_f32 v165, v166, v167
    ds_write_b64 v7, v[164:165] offset:44864
    s_waitcnt lgkmcnt(0)
    s_barrier
    v_mfma_f32_16x16x32_bf16 v[116:119], v[44:47], v[148:151], 0
    v_mfma_f32_16x16x32_bf16 v[120:123], v[48:51], v[148:151], 0
    v_mfma_f32_16x16x32_bf16 v[124:127], v[52:55], v[148:151], 0
    v_mfma_f32_16x16x32_bf16 v[128:131], v[56:59], v[148:151], 0
    v_mfma_f32_16x16x32_bf16 v[132:135], v[60:63], v[148:151], 0
    v_mfma_f32_16x16x32_bf16 v[136:139], v[64:67], v[148:151], 0
    v_mfma_f32_16x16x32_bf16 v[116:119], v[68:71], v[152:155], v[116:119]
    ds_read_b128 v[148:151], v5 offset:40000
    v_mfma_f32_16x16x32_bf16 v[120:123], v[72:75], v[152:155], v[120:123]
    v_mfma_f32_16x16x32_bf16 v[124:127], v[76:79], v[152:155], v[124:127]
    v_mfma_f32_16x16x32_bf16 v[128:131], v[80:83], v[152:155], v[128:131]
    v_mfma_f32_16x16x32_bf16 v[132:135], v[84:87], v[152:155], v[132:135]
    v_mfma_f32_16x16x32_bf16 v[136:139], v[88:91], v[152:155], v[136:139]
    v_mfma_f32_16x16x32_bf16 v[116:119], v[92:95], v[140:143], v[116:119]
    ds_read_b128 v[152:155], v5 offset:40064
    v_mfma_f32_16x16x32_bf16 v[120:123], v[96:99], v[140:143], v[120:123]
    v_mfma_f32_16x16x32_bf16 v[124:127], v[100:103], v[140:143], v[124:127]
    v_mfma_f32_16x16x32_bf16 v[128:131], v[104:107], v[140:143], v[128:131]
    v_mfma_f32_16x16x32_bf16 v[132:135], v[108:111], v[140:143], v[132:135]
    v_mfma_f32_16x16x32_bf16 v[136:139], v[112:115], v[140:143], v[136:139]
    v_mfma_f32_16x16x32_bf16 v[156:159], v[8:11], v[144:147], 0
    s_nop 0
    v_mul_f32 v116, s56, v116
    v_mul_f32 v117, s56, v117
    ds_read_b128 v[140:143], v5 offset:43008
    v_mfma_f32_16x16x32_bf16 v[160:163], v[12:15], v[144:147], 0
    v_mul_f32 v118, s56, v118
    v_mul_f32 v119, s56, v119
    v_mul_f32 v120, s56, v120
    v_mfma_f32_16x16x32_bf16 v[164:167], v[16:19], v[144:147], 0
    v_mul_f32 v121, s56, v121
    v_mul_f32 v122, s56, v122
    v_mul_f32 v123, s56, v123
    s_waitcnt lgkmcnt(2)
    v_mfma_f32_16x16x32_bf16 v[156:159], v[20:23], v[148:151], v[156:159]
    v_cvt_pk_bf16_f32 v116, v116, v117
    v_cvt_pk_bf16_f32 v117, v118, v119
    v_cvt_pk_bf16_f32 v118, v120, v121
    ds_read_b128 v[144:147], v5 offset:43072
    v_mfma_f32_16x16x32_bf16 v[160:163], v[24:27], v[148:151], v[160:163]
    v_cvt_pk_bf16_f32 v119, v122, v123
    ds_write_b128 v4, v[116:119] offset:6144
    v_mul_f32 v124, s56, v124
    v_mfma_f32_16x16x32_bf16 v[164:167], v[28:31], v[148:151], v[164:167]
    v_mul_f32 v125, s56, v125
    v_mul_f32 v126, s56, v126
    v_mul_f32 v127, s56, v127
    s_waitcnt lgkmcnt(3)
    v_mfma_f32_16x16x32_bf16 v[156:159], v[32:35], v[152:155], v[156:159]
    v_mul_f32 v128, s56, v128
    v_mul_f32 v129, s56, v129
    v_mul_f32 v130, s56, v130
    ds_read_b128 v[148:151], v5 offset:43136
    v_mfma_f32_16x16x32_bf16 v[160:163], v[36:39], v[152:155], v[160:163]
    v_mul_f32 v131, s56, v131
    v_cvt_pk_bf16_f32 v124, v124, v125
    v_cvt_pk_bf16_f32 v125, v126, v127
    v_mfma_f32_16x16x32_bf16 v[164:167], v[40:43], v[152:155], v[164:167]
    v_cvt_pk_bf16_f32 v126, v128, v129
    v_cvt_pk_bf16_f32 v127, v130, v131
    ds_write_b128 v4, v[124:127] offset:6400
    s_waitcnt lgkmcnt(4)
    v_mfma_f32_16x16x32_bf16 v[116:119], v[8:11], v[140:143], 0
    v_cvt_pk_bf16_f32 v156, v156, v157
    v_cvt_pk_bf16_f32 v157, v158, v159
    v_add_u32 v5, 46080, v5
    ds_read_b128 v[152:155], v5 offset:0
    v_mfma_f32_16x16x32_bf16 v[120:123], v[12:15], v[140:143], 0
    v_cvt_pk_bf16_f32 v158, v160, v161
    v_cvt_pk_bf16_f32 v159, v162, v163
    v_mfma_f32_16x16x32_bf16 v[124:127], v[16:19], v[140:143], 0
    ds_write_b128 v6, v[156:159] offset:51200
    v_cvt_pk_bf16_f32 v164, v164, v165
    v_cvt_pk_bf16_f32 v165, v166, v167
    s_waitcnt lgkmcnt(5)
    v_mfma_f32_16x16x32_bf16 v[116:119], v[20:23], v[144:147], v[116:119]
    ds_write_b64 v7, v[164:165] offset:51264
    v_mul_f32 v132, s56, v132
    ds_read_b128 v[140:143], v5 offset:64
    v_mfma_f32_16x16x32_bf16 v[120:123], v[24:27], v[144:147], v[120:123]
    v_mul_f32 v133, s56, v133
    v_mul_f32 v134, s56, v134
    v_mfma_f32_16x16x32_bf16 v[124:127], v[28:31], v[144:147], v[124:127]
    v_mul_f32 v135, s56, v135
    v_mul_f32 v136, s56, v136
    v_mul_f32 v137, s56, v137
    s_waitcnt lgkmcnt(5)
    v_mfma_f32_16x16x32_bf16 v[116:119], v[32:35], v[148:151], v[116:119]
    v_mul_f32 v138, s56, v138
    v_mul_f32 v139, s56, v139
    ds_read_b128 v[144:147], v5 offset:128
    v_mfma_f32_16x16x32_bf16 v[120:123], v[36:39], v[148:151], v[120:123]
    v_cvt_pk_bf16_f32 v132, v132, v133
    v_cvt_pk_bf16_f32 v133, v134, v135
    v_mfma_f32_16x16x32_bf16 v[124:127], v[40:43], v[148:151], v[124:127]
    v_cvt_pk_bf16_f32 v134, v136, v137
    v_cvt_pk_bf16_f32 v135, v138, v139
    ds_write_b128 v4, v[132:135] offset:6656
    s_waitcnt lgkmcnt(5)
    v_mfma_f32_16x16x32_bf16 v[156:159], v[8:11], v[152:155], 0
    ds_read_b128 v[148:151], v3 offset:30720
    v_mfma_f32_16x16x32_bf16 v[160:163], v[12:15], v[152:155], 0
    v_cvt_pk_bf16_f32 v116, v116, v117
    v_mfma_f32_16x16x32_bf16 v[164:167], v[16:19], v[152:155], 0
    v_cvt_pk_bf16_f32 v117, v118, v119
    s_waitcnt lgkmcnt(3)
    v_mfma_f32_16x16x32_bf16 v[156:159], v[20:23], v[140:143], v[156:159]
    v_cvt_pk_bf16_f32 v118, v120, v121
    ds_read_b128 v[152:155], v3 offset:30784
    v_mfma_f32_16x16x32_bf16 v[160:163], v[24:27], v[140:143], v[160:163]
    v_cvt_pk_bf16_f32 v119, v122, v123
    v_mfma_f32_16x16x32_bf16 v[164:167], v[28:31], v[140:143], v[164:167]
    ds_write_b128 v6, v[116:119] offset:57600
    s_waitcnt lgkmcnt(4)
    v_mfma_f32_16x16x32_bf16 v[156:159], v[32:35], v[144:147], v[156:159]
    v_cvt_pk_bf16_f32 v124, v124, v125
    ds_read_b128 v[140:143], v3 offset:30848
    v_mfma_f32_16x16x32_bf16 v[160:163], v[36:39], v[144:147], v[160:163]
    v_cvt_pk_bf16_f32 v125, v126, v127
    v_mfma_f32_16x16x32_bf16 v[164:167], v[40:43], v[144:147], v[164:167]
    ds_write_b64 v7, v[124:125] offset:57664
    ds_read_b128 v[144:147], v5 offset:3072
    s_nop 0
    v_cvt_pk_bf16_f32 v156, v156, v157
    v_cvt_pk_bf16_f32 v157, v158, v159
    s_nop 0
    v_cvt_pk_bf16_f32 v158, v160, v161
    v_cvt_pk_bf16_f32 v159, v162, v163
    ds_write_b128 v6, v[156:159] offset:0
    v_cvt_pk_bf16_f32 v164, v164, v165
    v_cvt_pk_bf16_f32 v165, v166, v167
    ds_write_b64 v7, v[164:165] offset:64
    s_waitcnt lgkmcnt(0)
    s_barrier
    v_mfma_f32_16x16x32_bf16 v[116:119], v[44:47], v[148:151], 0
    v_mfma_f32_16x16x32_bf16 v[120:123], v[48:51], v[148:151], 0
    v_mfma_f32_16x16x32_bf16 v[124:127], v[52:55], v[148:151], 0
    v_mfma_f32_16x16x32_bf16 v[128:131], v[56:59], v[148:151], 0
    v_mfma_f32_16x16x32_bf16 v[132:135], v[60:63], v[148:151], 0
    v_mfma_f32_16x16x32_bf16 v[136:139], v[64:67], v[148:151], 0
    v_mfma_f32_16x16x32_bf16 v[116:119], v[68:71], v[152:155], v[116:119]
    ds_read_b128 v[148:151], v5 offset:3136
    v_mfma_f32_16x16x32_bf16 v[120:123], v[72:75], v[152:155], v[120:123]
    v_mfma_f32_16x16x32_bf16 v[124:127], v[76:79], v[152:155], v[124:127]
    v_mfma_f32_16x16x32_bf16 v[128:131], v[80:83], v[152:155], v[128:131]
    v_mfma_f32_16x16x32_bf16 v[132:135], v[84:87], v[152:155], v[132:135]
    v_mfma_f32_16x16x32_bf16 v[136:139], v[88:91], v[152:155], v[136:139]
    v_mfma_f32_16x16x32_bf16 v[116:119], v[92:95], v[140:143], v[116:119]
    ds_read_b128 v[152:155], v5 offset:3200
    v_mfma_f32_16x16x32_bf16 v[120:123], v[96:99], v[140:143], v[120:123]
    v_mfma_f32_16x16x32_bf16 v[124:127], v[100:103], v[140:143], v[124:127]
    v_mfma_f32_16x16x32_bf16 v[128:131], v[104:107], v[140:143], v[128:131]
    v_mfma_f32_16x16x32_bf16 v[132:135], v[108:111], v[140:143], v[132:135]
    v_mfma_f32_16x16x32_bf16 v[136:139], v[112:115], v[140:143], v[136:139]
    v_mfma_f32_16x16x32_bf16 v[156:159], v[8:11], v[144:147], 0
    s_nop 0
    v_mul_f32 v116, s56, v116
    v_mul_f32 v117, s56, v117
    ds_read_b128 v[140:143], v5 offset:6144
    v_mfma_f32_16x16x32_bf16 v[160:163], v[12:15], v[144:147], 0
    v_mul_f32 v118, s56, v118
    v_mul_f32 v119, s56, v119
    v_mul_f32 v120, s56, v120
    v_mfma_f32_16x16x32_bf16 v[164:167], v[16:19], v[144:147], 0
    v_mul_f32 v121, s56, v121
    v_mul_f32 v122, s56, v122
    v_mul_f32 v123, s56, v123
    s_waitcnt lgkmcnt(2)
    v_mfma_f32_16x16x32_bf16 v[156:159], v[20:23], v[148:151], v[156:159]
    v_cvt_pk_bf16_f32 v116, v116, v117
    v_cvt_pk_bf16_f32 v117, v118, v119
    v_cvt_pk_bf16_f32 v118, v120, v121
    ds_read_b128 v[144:147], v5 offset:6208
    v_mfma_f32_16x16x32_bf16 v[160:163], v[24:27], v[148:151], v[160:163]
    v_cvt_pk_bf16_f32 v119, v122, v123
    ds_write_b128 v4, v[116:119] offset:12288
    v_mul_f32 v124, s56, v124
    v_mfma_f32_16x16x32_bf16 v[164:167], v[28:31], v[148:151], v[164:167]
    v_mul_f32 v125, s56, v125
    v_mul_f32 v126, s56, v126
    v_mul_f32 v127, s56, v127
    s_waitcnt lgkmcnt(3)
    v_mfma_f32_16x16x32_bf16 v[156:159], v[32:35], v[152:155], v[156:159]
    v_mul_f32 v128, s56, v128
    v_mul_f32 v129, s56, v129
    v_mul_f32 v130, s56, v130
    ds_read_b128 v[148:151], v5 offset:6272
    v_mfma_f32_16x16x32_bf16 v[160:163], v[36:39], v[152:155], v[160:163]
    v_mul_f32 v131, s56, v131
    v_cvt_pk_bf16_f32 v124, v124, v125
    v_cvt_pk_bf16_f32 v125, v126, v127
    v_mfma_f32_16x16x32_bf16 v[164:167], v[40:43], v[152:155], v[164:167]
    v_cvt_pk_bf16_f32 v126, v128, v129
    v_cvt_pk_bf16_f32 v127, v130, v131
    ds_write_b128 v4, v[124:127] offset:12544
    s_waitcnt lgkmcnt(4)
    v_mfma_f32_16x16x32_bf16 v[116:119], v[8:11], v[140:143], 0
    v_cvt_pk_bf16_f32 v156, v156, v157
    v_cvt_pk_bf16_f32 v157, v158, v159
    ds_read_b128 v[152:155], v5 offset:9216
    v_mfma_f32_16x16x32_bf16 v[120:123], v[12:15], v[140:143], 0
    v_cvt_pk_bf16_f32 v158, v160, v161
    v_cvt_pk_bf16_f32 v159, v162, v163
    v_mfma_f32_16x16x32_bf16 v[124:127], v[16:19], v[140:143], 0
    ds_write_b128 v6, v[156:159] offset:6400
    v_cvt_pk_bf16_f32 v164, v164, v165
    v_cvt_pk_bf16_f32 v165, v166, v167
    s_waitcnt lgkmcnt(5)
    v_mfma_f32_16x16x32_bf16 v[116:119], v[20:23], v[144:147], v[116:119]
    ds_write_b64 v7, v[164:165] offset:6464
    v_mul_f32 v132, s56, v132
    ds_read_b128 v[140:143], v5 offset:9280
    v_mfma_f32_16x16x32_bf16 v[120:123], v[24:27], v[144:147], v[120:123]
    v_mul_f32 v133, s56, v133
    v_mul_f32 v134, s56, v134
    v_mfma_f32_16x16x32_bf16 v[124:127], v[28:31], v[144:147], v[124:127]
    v_mul_f32 v135, s56, v135
    v_mul_f32 v136, s56, v136
    v_mul_f32 v137, s56, v137
    s_waitcnt lgkmcnt(5)
    v_mfma_f32_16x16x32_bf16 v[116:119], v[32:35], v[148:151], v[116:119]
    v_mul_f32 v138, s56, v138
    v_mul_f32 v139, s56, v139
    ds_read_b128 v[144:147], v5 offset:9344
    v_mfma_f32_16x16x32_bf16 v[120:123], v[36:39], v[148:151], v[120:123]
    v_cvt_pk_bf16_f32 v132, v132, v133
    v_cvt_pk_bf16_f32 v133, v134, v135
    v_mfma_f32_16x16x32_bf16 v[124:127], v[40:43], v[148:151], v[124:127]
    v_cvt_pk_bf16_f32 v134, v136, v137
    v_cvt_pk_bf16_f32 v135, v138, v139
    ds_write_b128 v4, v[132:135] offset:12800
    s_waitcnt lgkmcnt(5)
    v_mfma_f32_16x16x32_bf16 v[156:159], v[8:11], v[152:155], 0
    ds_read_b128 v[148:151], v2 offset:38400
    v_mfma_f32_16x16x32_bf16 v[160:163], v[12:15], v[152:155], 0
    v_cvt_pk_bf16_f32 v116, v116, v117
    v_mfma_f32_16x16x32_bf16 v[164:167], v[16:19], v[152:155], 0
    v_cvt_pk_bf16_f32 v117, v118, v119
    s_waitcnt lgkmcnt(3)
    v_mfma_f32_16x16x32_bf16 v[156:159], v[20:23], v[140:143], v[156:159]
    v_cvt_pk_bf16_f32 v118, v120, v121
    ds_read_b128 v[152:155], v2 offset:38464
    v_mfma_f32_16x16x32_bf16 v[160:163], v[24:27], v[140:143], v[160:163]
    v_cvt_pk_bf16_f32 v119, v122, v123
    v_mfma_f32_16x16x32_bf16 v[164:167], v[28:31], v[140:143], v[164:167]
    ds_write_b128 v6, v[116:119] offset:12800
    s_waitcnt lgkmcnt(4)
    v_mfma_f32_16x16x32_bf16 v[156:159], v[32:35], v[144:147], v[156:159]
    v_cvt_pk_bf16_f32 v124, v124, v125
    ds_read_b128 v[140:143], v2 offset:38528
    v_mfma_f32_16x16x32_bf16 v[160:163], v[36:39], v[144:147], v[160:163]
    v_cvt_pk_bf16_f32 v125, v126, v127
    v_mfma_f32_16x16x32_bf16 v[164:167], v[40:43], v[144:147], v[164:167]
    ds_write_b64 v7, v[124:125] offset:12864
    ds_read_b128 v[144:147], v5 offset:12288
    s_nop 0
    v_cvt_pk_bf16_f32 v156, v156, v157
    v_cvt_pk_bf16_f32 v157, v158, v159
    s_nop 0
    v_cvt_pk_bf16_f32 v158, v160, v161
    v_cvt_pk_bf16_f32 v159, v162, v163
    ds_write_b128 v6, v[156:159] offset:19200
    v_cvt_pk_bf16_f32 v164, v164, v165
    v_cvt_pk_bf16_f32 v165, v166, v167
    ds_write_b64 v7, v[164:165] offset:19264
    s_waitcnt lgkmcnt(0)
    s_barrier
    v_mfma_f32_16x16x32_bf16 v[116:119], v[44:47], v[148:151], 0
    v_mfma_f32_16x16x32_bf16 v[120:123], v[48:51], v[148:151], 0
    v_mfma_f32_16x16x32_bf16 v[124:127], v[52:55], v[148:151], 0
    v_mfma_f32_16x16x32_bf16 v[128:131], v[56:59], v[148:151], 0
    v_mfma_f32_16x16x32_bf16 v[132:135], v[60:63], v[148:151], 0
    v_mfma_f32_16x16x32_bf16 v[136:139], v[64:67], v[148:151], 0
    v_mfma_f32_16x16x32_bf16 v[116:119], v[68:71], v[152:155], v[116:119]
    ds_read_b128 v[148:151], v5 offset:12352
    v_mfma_f32_16x16x32_bf16 v[120:123], v[72:75], v[152:155], v[120:123]
    v_mfma_f32_16x16x32_bf16 v[124:127], v[76:79], v[152:155], v[124:127]
    v_mfma_f32_16x16x32_bf16 v[128:131], v[80:83], v[152:155], v[128:131]
    v_mfma_f32_16x16x32_bf16 v[132:135], v[84:87], v[152:155], v[132:135]
    v_mfma_f32_16x16x32_bf16 v[136:139], v[88:91], v[152:155], v[136:139]
    v_mfma_f32_16x16x32_bf16 v[116:119], v[92:95], v[140:143], v[116:119]
    ds_read_b128 v[152:155], v5 offset:12416
    v_mfma_f32_16x16x32_bf16 v[120:123], v[96:99], v[140:143], v[120:123]
    v_mfma_f32_16x16x32_bf16 v[124:127], v[100:103], v[140:143], v[124:127]
    v_mfma_f32_16x16x32_bf16 v[128:131], v[104:107], v[140:143], v[128:131]
    v_mfma_f32_16x16x32_bf16 v[132:135], v[108:111], v[140:143], v[132:135]
    v_mfma_f32_16x16x32_bf16 v[136:139], v[112:115], v[140:143], v[136:139]
    v_mfma_f32_16x16x32_bf16 v[156:159], v[8:11], v[144:147], 0
    s_nop 0
    v_mul_f32 v116, s56, v116
    v_mul_f32 v117, s56, v117
    ds_read_b128 v[140:143], v5 offset:15360
    v_mfma_f32_16x16x32_bf16 v[160:163], v[12:15], v[144:147], 0
    v_mul_f32 v118, s56, v118
    v_mul_f32 v119, s56, v119
    v_mul_f32 v120, s56, v120
    v_mfma_f32_16x16x32_bf16 v[164:167], v[16:19], v[144:147], 0
    v_mul_f32 v121, s56, v121
    v_mul_f32 v122, s56, v122
    v_mul_f32 v123, s56, v123
    s_waitcnt lgkmcnt(2)
    v_mfma_f32_16x16x32_bf16 v[156:159], v[20:23], v[148:151], v[156:159]
    v_cvt_pk_bf16_f32 v116, v116, v117
    v_cvt_pk_bf16_f32 v117, v118, v119
    v_cvt_pk_bf16_f32 v118, v120, v121
    ds_read_b128 v[144:147], v5 offset:15424
    v_mfma_f32_16x16x32_bf16 v[160:163], v[24:27], v[148:151], v[160:163]
    v_cvt_pk_bf16_f32 v119, v122, v123
    ds_write_b128 v4, v[116:119] offset:0
    v_mul_f32 v124, s56, v124
    v_mfma_f32_16x16x32_bf16 v[164:167], v[28:31], v[148:151], v[164:167]
    v_mul_f32 v125, s56, v125
    v_mul_f32 v126, s56, v126
    v_mul_f32 v127, s56, v127
    s_waitcnt lgkmcnt(3)
    v_mfma_f32_16x16x32_bf16 v[156:159], v[32:35], v[152:155], v[156:159]
    v_mul_f32 v128, s56, v128
    v_mul_f32 v129, s56, v129
    v_mul_f32 v130, s56, v130
    ds_read_b128 v[148:151], v5 offset:15488
    v_mfma_f32_16x16x32_bf16 v[160:163], v[36:39], v[152:155], v[160:163]
    v_mul_f32 v131, s56, v131
    v_cvt_pk_bf16_f32 v124, v124, v125
    v_cvt_pk_bf16_f32 v125, v126, v127
    v_mfma_f32_16x16x32_bf16 v[164:167], v[40:43], v[152:155], v[164:167]
    v_cvt_pk_bf16_f32 v126, v128, v129
    v_cvt_pk_bf16_f32 v127, v130, v131
    ds_write_b128 v4, v[124:127] offset:256
    s_waitcnt lgkmcnt(4)
    v_mfma_f32_16x16x32_bf16 v[116:119], v[8:11], v[140:143], 0
    v_cvt_pk_bf16_f32 v156, v156, v157
    v_cvt_pk_bf16_f32 v157, v158, v159
    ds_read_b128 v[152:155], v5 offset:18432
    v_mfma_f32_16x16x32_bf16 v[120:123], v[12:15], v[140:143], 0
    v_cvt_pk_bf16_f32 v158, v160, v161
    v_cvt_pk_bf16_f32 v159, v162, v163
    v_mfma_f32_16x16x32_bf16 v[124:127], v[16:19], v[140:143], 0
    ds_write_b128 v6, v[156:159] offset:25600
    v_cvt_pk_bf16_f32 v164, v164, v165
    v_cvt_pk_bf16_f32 v165, v166, v167
    s_waitcnt lgkmcnt(5)
    v_mfma_f32_16x16x32_bf16 v[116:119], v[20:23], v[144:147], v[116:119]
    ds_write_b64 v7, v[164:165] offset:25664
    v_mul_f32 v132, s56, v132
    ds_read_b128 v[140:143], v5 offset:18496
    v_mfma_f32_16x16x32_bf16 v[120:123], v[24:27], v[144:147], v[120:123]
    v_mul_f32 v133, s56, v133
    v_mul_f32 v134, s56, v134
    v_mfma_f32_16x16x32_bf16 v[124:127], v[28:31], v[144:147], v[124:127]
    v_mul_f32 v135, s56, v135
    v_mul_f32 v136, s56, v136
    v_mul_f32 v137, s56, v137
    s_waitcnt lgkmcnt(5)
    v_mfma_f32_16x16x32_bf16 v[116:119], v[32:35], v[148:151], v[116:119]
    v_mul_f32 v138, s56, v138
    v_mul_f32 v139, s56, v139
    ds_read_b128 v[144:147], v5 offset:18560
    v_mfma_f32_16x16x32_bf16 v[120:123], v[36:39], v[148:151], v[120:123]
    v_cvt_pk_bf16_f32 v132, v132, v133
    v_cvt_pk_bf16_f32 v133, v134, v135
    v_mfma_f32_16x16x32_bf16 v[124:127], v[40:43], v[148:151], v[124:127]
    v_cvt_pk_bf16_f32 v134, v136, v137
    v_cvt_pk_bf16_f32 v135, v138, v139
    ds_write_b128 v4, v[132:135] offset:512
    s_waitcnt lgkmcnt(5)
    v_mfma_f32_16x16x32_bf16 v[156:159], v[8:11], v[152:155], 0
    ds_read_b128 v[148:151], v3 offset:46080
    v_mfma_f32_16x16x32_bf16 v[160:163], v[12:15], v[152:155], 0
    v_cvt_pk_bf16_f32 v116, v116, v117
    v_mfma_f32_16x16x32_bf16 v[164:167], v[16:19], v[152:155], 0
    v_cvt_pk_bf16_f32 v117, v118, v119
    s_waitcnt lgkmcnt(3)
    v_mfma_f32_16x16x32_bf16 v[156:159], v[20:23], v[140:143], v[156:159]
    v_cvt_pk_bf16_f32 v118, v120, v121
    ds_read_b128 v[152:155], v3 offset:46144
    v_mfma_f32_16x16x32_bf16 v[160:163], v[24:27], v[140:143], v[160:163]
    v_cvt_pk_bf16_f32 v119, v122, v123
    v_mfma_f32_16x16x32_bf16 v[164:167], v[28:31], v[140:143], v[164:167]
    ds_write_b128 v6, v[116:119] offset:32000
    s_waitcnt lgkmcnt(4)
    v_mfma_f32_16x16x32_bf16 v[156:159], v[32:35], v[144:147], v[156:159]
    v_cvt_pk_bf16_f32 v124, v124, v125
    ds_read_b128 v[140:143], v3 offset:46208
    v_mfma_f32_16x16x32_bf16 v[160:163], v[36:39], v[144:147], v[160:163]
    v_cvt_pk_bf16_f32 v125, v126, v127
    v_mfma_f32_16x16x32_bf16 v[164:167], v[40:43], v[144:147], v[164:167]
    ds_write_b64 v7, v[124:125] offset:32064
    ds_read_b128 v[144:147], v5 offset:21504
    s_nop 0
    v_cvt_pk_bf16_f32 v156, v156, v157
    v_cvt_pk_bf16_f32 v157, v158, v159
    s_nop 0
    v_cvt_pk_bf16_f32 v158, v160, v161
    v_cvt_pk_bf16_f32 v159, v162, v163
    ds_write_b128 v6, v[156:159] offset:38400
    v_cvt_pk_bf16_f32 v164, v164, v165
    v_cvt_pk_bf16_f32 v165, v166, v167
    ds_write_b64 v7, v[164:165] offset:38464
    s_waitcnt lgkmcnt(0)
    s_barrier
    v_mfma_f32_16x16x32_bf16 v[116:119], v[44:47], v[148:151], 0
    v_mfma_f32_16x16x32_bf16 v[120:123], v[48:51], v[148:151], 0
    v_mfma_f32_16x16x32_bf16 v[124:127], v[52:55], v[148:151], 0
    v_mfma_f32_16x16x32_bf16 v[128:131], v[56:59], v[148:151], 0
    v_mfma_f32_16x16x32_bf16 v[132:135], v[60:63], v[148:151], 0
    v_mfma_f32_16x16x32_bf16 v[136:139], v[64:67], v[148:151], 0
    v_mfma_f32_16x16x32_bf16 v[116:119], v[68:71], v[152:155], v[116:119]
    ds_read_b128 v[148:151], v5 offset:21568
    v_mfma_f32_16x16x32_bf16 v[120:123], v[72:75], v[152:155], v[120:123]
    v_mfma_f32_16x16x32_bf16 v[124:127], v[76:79], v[152:155], v[124:127]
    v_mfma_f32_16x16x32_bf16 v[128:131], v[80:83], v[152:155], v[128:131]
    v_mfma_f32_16x16x32_bf16 v[132:135], v[84:87], v[152:155], v[132:135]
    v_mfma_f32_16x16x32_bf16 v[136:139], v[88:91], v[152:155], v[136:139]
    v_mfma_f32_16x16x32_bf16 v[116:119], v[92:95], v[140:143], v[116:119]
    ds_read_b128 v[152:155], v5 offset:21632
    v_mfma_f32_16x16x32_bf16 v[120:123], v[96:99], v[140:143], v[120:123]
    v_mfma_f32_16x16x32_bf16 v[124:127], v[100:103], v[140:143], v[124:127]
    v_mfma_f32_16x16x32_bf16 v[128:131], v[104:107], v[140:143], v[128:131]
    v_mfma_f32_16x16x32_bf16 v[132:135], v[108:111], v[140:143], v[132:135]
    v_mfma_f32_16x16x32_bf16 v[136:139], v[112:115], v[140:143], v[136:139]
    s_sub_u32 s62, s6, 1
    s_cmp_ge_u32 s62, 6
    s_cbranch_scc1 L_edgeq
    v_mfma_f32_16x16x32_bf16 v[156:159], v[8:11], v[144:147], 0
    v_mul_f32 v116, s56, v116
    v_mul_f32 v117, s56, v117
    ds_read_b128 v[140:143], v5 offset:24576
    v_mfma_f32_16x16x32_bf16 v[160:163], v[12:15], v[144:147], 0
    v_mul_f32 v118, s56, v118
    v_mul_f32 v119, s56, v119
    v_mul_f32 v120, s56, v120
    v_mfma_f32_16x16x32_bf16 v[164:167], v[16:19], v[144:147], 0
    v_mul_f32 v121, s56, v121
    v_mul_f32 v122, s56, v122
    v_mul_f32 v123, s56, v123
    s_waitcnt lgkmcnt(2)
    v_mfma_f32_16x16x32_bf16 v[156:159], v[20:23], v[148:151], v[156:159]
    v_cvt_pk_bf16_f32 v116, v116, v117
    v_cvt_pk_bf16_f32 v117, v118, v119
    v_cvt_pk_bf16_f32 v118, v120, v121
    ds_read_b128 v[144:147], v5 offset:24640
    v_mfma_f32_16x16x32_bf16 v[160:163], v[24:27], v[148:151], v[160:163]
    v_cvt_pk_bf16_f32 v119, v122, v123
    ds_write_b128 v4, v[116:119] offset:6144
    v_mul_f32 v124, s56, v124
    v_mfma_f32_16x16x32_bf16 v[164:167], v[28:31], v[148:151], v[164:167]
    v_mul_f32 v125, s56, v125
    v_mul_f32 v126, s56, v126
    v_mul_f32 v127, s56, v127
    s_waitcnt lgkmcnt(3)
    v_mfma_f32_16x16x32_bf16 v[156:159], v[32:35], v[152:155], v[156:159]
    v_mul_f32 v128, s56, v128
    v_mul_f32 v129, s56, v129
    v_mul_f32 v130, s56, v130
    ds_read_b128 v[148:151], v5 offset:24704
    v_mfma_f32_16x16x32_bf16 v[160:163], v[36:39], v[152:155], v[160:163]
    v_mul_f32 v131, s56, v131
    v_cvt_pk_bf16_f32 v124, v124, v125
    v_cvt_pk_bf16_f32 v125, v126, v127
    v_mfma_f32_16x16x32_bf16 v[164:167], v[40:43], v[152:155], v[164:167]
    v_cvt_pk_bf16_f32 v126, v128, v129
    v_cvt_pk_bf16_f32 v127, v130, v131
    ds_write_b128 v4, v[124:127] offset:6400
    s_waitcnt lgkmcnt(4)
    v_mfma_f32_16x16x32_bf16 v[116:119], v[8:11], v[140:143], 0
    v_cvt_pk_bf16_f32 v156, v156, v157
    v_cvt_pk_bf16_f32 v157, v158, v159
    ds_read_b128 v[152:155], v5 offset:27648
    v_mfma_f32_16x16x32_bf16 v[120:123], v[12:15], v[140:143], 0
    v_cvt_pk_bf16_f32 v158, v160, v161
    v_cvt_pk_bf16_f32 v159, v162, v163
    v_mfma_f32_16x16x32_bf16 v[124:127], v[16:19], v[140:143], 0
    ds_write_b128 v6, v[156:159] offset:44800
    v_cvt_pk_bf16_f32 v164, v164, v165
    v_cvt_pk_bf16_f32 v165, v166, v167
    s_waitcnt lgkmcnt(5)
    v_mfma_f32_16x16x32_bf16 v[116:119], v[20:23], v[144:147], v[116:119]
    ds_write_b64 v7, v[164:165] offset:44864
    v_mul_f32 v132, s56, v132
    ds_read_b128 v[140:143], v5 offset:27712
    v_mfma_f32_16x16x32_bf16 v[120:123], v[24:27], v[144:147], v[120:123]
    v_mul_f32 v133, s56, v133
    v_mul_f32 v134, s56, v134
    v_mfma_f32_16x16x32_bf16 v[124:127], v[28:31], v[144:147], v[124:127]
    v_mul_f32 v135, s56, v135
    v_mul_f32 v136, s56, v136
    v_mul_f32 v137, s56, v137
    s_waitcnt lgkmcnt(5)
    v_mfma_f32_16x16x32_bf16 v[116:119], v[32:35], v[148:151], v[116:119]
    v_mul_f32 v138, s56, v138
    v_mul_f32 v139, s56, v139
    ds_read_b128 v[144:147], v5 offset:27776
    v_mfma_f32_16x16x32_bf16 v[120:123], v[36:39], v[148:151], v[120:123]
    v_cvt_pk_bf16_f32 v132, v132, v133
    v_cvt_pk_bf16_f32 v133, v134, v135
    v_mfma_f32_16x16x32_bf16 v[124:127], v[40:43], v[148:151], v[124:127]
    v_cvt_pk_bf16_f32 v134, v136, v137
    v_cvt_pk_bf16_f32 v135, v138, v139
    ds_write_b128 v4, v[132:135] offset:6656
    s_waitcnt lgkmcnt(5)
    v_mfma_f32_16x16x32_bf16 v[156:159], v[8:11], v[152:155], 0
    v_mfma_f32_16x16x32_bf16 v[160:163], v[12:15], v[152:155], 0
    v_cvt_pk_bf16_f32 v116, v116, v117
    v_mfma_f32_16x16x32_bf16 v[164:167], v[16:19], v[152:155], 0
    v_cvt_pk_bf16_f32 v117, v118, v119
    s_waitcnt lgkmcnt(2)
    v_mfma_f32_16x16x32_bf16 v[156:159], v[20:23], v[140:143], v[156:159]
    v_cvt_pk_bf16_f32 v118, v120, v121
    v_mfma_f32_16x16x32_bf16 v[160:163], v[24:27], v[140:143], v[160:163]
    v_cvt_pk_bf16_f32 v119, v122, v123
    v_mfma_f32_16x16x32_bf16 v[164:167], v[28:31], v[140:143], v[164:167]
    ds_write_b128 v6, v[116:119] offset:51200
    s_waitcnt lgkmcnt(2)
    v_mfma_f32_16x16x32_bf16 v[156:159], v[32:35], v[144:147], v[156:159]
    v_cvt_pk_bf16_f32 v124, v124, v125
    v_mfma_f32_16x16x32_bf16 v[160:163], v[36:39], v[144:147], v[160:163]
    v_cvt_pk_bf16_f32 v125, v126, v127
    v_mfma_f32_16x16x32_bf16 v[164:167], v[40:43], v[144:147], v[164:167]
    ds_write_b64 v7, v[124:125] offset:51264
    s_nop 2
    v_cvt_pk_bf16_f32 v156, v156, v157
    v_cvt_pk_bf16_f32 v157, v158, v159
    v_cvt_pk_bf16_f32 v158, v160, v161
    v_cvt_pk_bf16_f32 v159, v162, v163
    ds_write_b128 v6, v[156:159] offset:57600
    v_cvt_pk_bf16_f32 v164, v164, v165
    v_cvt_pk_bf16_f32 v165, v166, v167
    ds_write_b64 v7, v[164:165] offset:57664
    s_waitcnt lgkmcnt(0)
    s_barrier
L_joinq:
    s_waitcnt lgkmcnt(0)
    s_barrier
    s_waitcnt lgkmcnt(0)
    s_barrier
    s_branch L_fin
L_prodO:
    s_load_dwordx2 s[24:25], s[0:1], 16
    s_load_dwordx2 s[32:33], s[0:1], 32
    s_sub_u32 s64, s64, 6
    v_add3_u32 v159, v126, s64, 24
    v_add3_u32 v157, v127, s64, 12
    v_bitop3_b32 v159, v159, v123, 2 bitop3:0x78
    v_bitop3_b32 v157, v157, v123, 2 bitop3:0x78
    v_lshl_add_u32 v159, v159, 4, v129
    v_lshl_add_u32 v157, v157, 4, v128
    v_xor_b32 v158, 8, v157
    s_mul_i32 s64, s6, 14
    v_and_b32 v82, 1, v0
    s_cmp_eq_u32 s6, 0
    v_mul_u32_u24 v82, 16000, v82
    s_cselect_b32 s64, 12, s64
    v_mov_b32 v80, 0x3f803f80
    s_cselect_b32 s41, -4, 4
    v_mov_b32 v81, 0x3f803f80
    s_cselect_b32 s62, 1, 0
    v_add_u32 v82, 100224, v82
    s_mov_b32 s42, 86016
    v_mov_b32 v126, 0
    s_mul_i32 s41, s41, s42
    ds_write_b64 v82, v[80:81] offset:32000
    s_lshr_b32 s61, s2, 4
    ds_write_b32 v126, v126 offset:0
    s_lshl4_add_u32 s64, s64, s61
    v_lshl_add_u32 v3, v120, 8, v130
    s_lshl1_add_u32 s64, s64, s53
    v_mul_u32_u24 v125, 1536, v120
    s_mul_i32 s64, s64, 7
    v_add_u32 v1, v125, v124
    s_bfe_u32 s63, s2, 0x10003
    v_lshrrev_b32 v125, 1, v120
    s_lshl1_add_u32 s64, s64, s63
    v_xor_b32 v125, s62, v125
    s_mul_i32 s43, s64, 192
    v_mad_u32_u24 v125, v125, s42, v124
    s_mov_b32 s26, 18432
    v_and_b32 v126, 1, v120
    s_mov_b32 s27, 0x20000
    v_mul_u32_u24 v126, 1536, v126
    s_mov_b32 s34, 9633792
    v_add_u32 v4, v125, v126
    s_mov_b32 s35, 0x20000
    s_mov_b64 s[46:47], 0
    s_movk_i32 s56, 0x207
    s_mov_b32 s44, 0xffff
    s_mov_b32 s45, 0xffff
    s_mov_b32 s57, 0x05040100
    s_mov_b32 s58, 0x07060302
    s_waitcnt vmcnt(2)
    v_lshlrev_b32 v132, 16, v132
    s_waitcnt vmcnt(1)
    v_lshlrev_b32 v133, 16, v133
    s_waitcnt vmcnt(0)
    v_lshlrev_b32 v134, 16, v134
    s_cmp_eq_u32 s37, 0
    s_cbranch_scc1 L_nfo
    v_swap_b32 v132, v134
L_nfo:
    v_mul_f32 v132, 0x3fb8aa3b, v132
    v_mul_f32 v133, 0x3fb8aa3b, v133
    v_mul_f32 v134, 0x3fb8aa3b, v134
    ds_write_b32 v131, v132 offset:512
    ds_write_b32 v131, v133 offset:784
    s_bfm_b64 exec, 16, 32
    v_mov_b32 v132, 0xff800000
    v_mov_b32 v134, 0xff800000
    s_mov_b32 exec_hi, -1
    ds_write_b32 v131, v132 offset:716
    s_mov_b32 exec_lo, -1
    ds_write_b32 v131, v133 offset:988
    ds_write_b32 v131, v134 offset:1260
    s_waitcnt lgkmcnt(0)
    s_barrier
    s_add_u32 m0, s59, 66048
    s_add_u32 s61, s59, 0
    buffer_load_dwordx4 v140, s[20:23], s61 offen offset:0 lds
    buffer_load_dwordx4 v140, s[20:23], s61 offen offset:1024 lds
    s_add_u32 m0, s59, 70144
    s_add_u32 s61, s59, 4096
    buffer_load_dwordx4 v141, s[20:23], s61 offen offset:1024 lds
    buffer_load_dwordx4 v141, s[20:23], s61 offen offset:2048 lds
    s_add_u32 m0, s59, 93696
    s_add_u32 s61, s59, 18432
    buffer_load_dwordx4 v140, s[20:23], s61 offen offset:0 lds
    buffer_load_dwordx4 v140, s[20:23], s61 offen offset:1024 lds
    s_add_u32 m0, s59, 97792
    s_add_u32 s61, s59, 22528
    buffer_load_dwordx4 v141, s[20:23], s61 offen offset:1024 lds
    buffer_load_dwordx4 v141, s[20:23], s61 offen offset:2048 lds
    s_waitcnt vmcnt(4) lgkmcnt(0)
    s_barrier
    s_add_u32 m0, s59, 112128
    s_add_u32 s61, s59, 36864
    buffer_load_dwordx4 v140, s[20:23], s61 offen offset:0 lds
    buffer_load_dwordx4 v140, s[20:23], s61 offen offset:1024 lds
    s_add_u32 m0, s59, 116224
    s_add_u32 s61, s59, 40960
    buffer_load_dwordx4 v141, s[20:23], s61 offen offset:1024 lds
    buffer_load_dwordx4 v141, s[20:23], s61 offen offset:2048 lds
    s_movk_i32 s59, 6144
    s_movk_i32 s60, 12288
    ds_read_b128 v[140:143], v5 offset:12288
    ds_read_b128 v[144:147], v5 offset:12352
    ds_read_b128 v[148:151], v5 offset:12416
    ds_read_b64_tr_b16 v[8:9], v161 offset:0
    ds_read_b64_tr_b16 v[10:11], v161 offset:2304
    ds_read_b64_tr_b16 v[12:13], v162 offset:0
    ds_read_b64_tr_b16 v[14:15], v162 offset:2304
    ds_read_b64_tr_b16 v[16:17], v163 offset:0
    ds_read_b64_tr_b16 v[18:19], v163 offset:2304
    ds_read_b64_tr_b16 v[44:45], v157 offset:0
    ds_read_b64_tr_b16 v[46:47], v157 offset:2304
    ds_read_b64_tr_b16 v[48:49], v158 offset:0
    ds_read_b64_tr_b16 v[50:51], v158 offset:2304
    ds_read_b64_tr_b16 v[52:53], v159 offset:0
    ds_read_b64_tr_b16 v[54:55], v159 offset:2304
    s_waitcnt lgkmcnt(10)
    v_mfma_f32_16x16x32_bf16 v[116:119], v[8:11], v[140:143], 0
    s_waitcnt lgkmcnt(8)
    v_mfma_f32_16x16x32_bf16 v[120:123], v[12:15], v[140:143], 0
    s_waitcnt lgkmcnt(6)
    v_mfma_f32_16x16x32_bf16 v[124:127], v[16:19], v[140:143], 0
    s_waitcnt lgkmcnt(4)
    v_mfma_f32_16x16x32_bf16 v[128:131], v[44:47], v[140:143], 0
    s_waitcnt lgkmcnt(2)
    v_mfma_f32_16x16x32_bf16 v[132:135], v[48:51], v[140:143], 0
    s_waitcnt lgkmcnt(0)
    v_mfma_f32_16x16x32_bf16 v[136:139], v[52:55], v[140:143], 0
    s_waitcnt vmcnt(0) lgkmcnt(0)
    s_barrier
    ds_read_b64_tr_b16 v[20:21], v161 offset:27648
    ds_read_b64_tr_b16 v[22:23], v161 offset:29952
    ds_read_b64_tr_b16 v[24:25], v162 offset:27648
    ds_read_b64_tr_b16 v[26:27], v162 offset:29952
    ds_read_b64_tr_b16 v[28:29], v163 offset:27648
    ds_read_b64_tr_b16 v[30:31], v163 offset:29952
    ds_read_b64_tr_b16 v[56:57], v157 offset:27648
    ds_read_b64_tr_b16 v[58:59], v157 offset:29952
    ds_read_b64_tr_b16 v[60:61], v158 offset:27648
    ds_read_b64_tr_b16 v[62:63], v158 offset:29952
    ds_read_b64_tr_b16 v[64:65], v159 offset:27648
    ds_read_b64_tr_b16 v[66:67], v159 offset:29952
    s_waitcnt lgkmcnt(10)
    v_mfma_f32_16x16x32_bf16 v[116:119], v[20:23], v[144:147], v[116:119]
    ds_read_b64_tr_b16 v[32:33], v161 offset:46080
    ds_read_b64_tr_b16 v[34:35], v161 offset:48384
    ds_read_b64_tr_b16 v[36:37], v162 offset:46080
    s_waitcnt lgkmcnt(11)
    v_mfma_f32_16x16x32_bf16 v[120:123], v[24:27], v[144:147], v[120:123]
    ds_read_b64_tr_b16 v[38:39], v162 offset:48384
    ds_read_b64_tr_b16 v[40:41], v163 offset:46080
    ds_read_b64_tr_b16 v[42:43], v163 offset:48384
    s_waitcnt lgkmcnt(12)
    v_mfma_f32_16x16x32_bf16 v[124:127], v[28:31], v[144:147], v[124:127]
    ds_read_b64_tr_b16 v[68:69], v157 offset:46080
    ds_read_b64_tr_b16 v[70:71], v157 offset:48384
    ds_read_b64_tr_b16 v[72:73], v158 offset:46080
    s_waitcnt lgkmcnt(13)
    v_mfma_f32_16x16x32_bf16 v[128:131], v[56:59], v[144:147], v[128:131]
    ds_read_b64_tr_b16 v[74:75], v158 offset:48384
    ds_read_b64_tr_b16 v[76:77], v159 offset:46080
    ds_read_b64_tr_b16 v[78:79], v159 offset:48384
    s_waitcnt lgkmcnt(14)
    v_mfma_f32_16x16x32_bf16 v[132:135], v[60:63], v[144:147], v[132:135]
    s_waitcnt lgkmcnt(12)
    v_mfma_f32_16x16x32_bf16 v[136:139], v[64:67], v[144:147], v[136:139]
    s_waitcnt lgkmcnt(10)
    v_mfma_f32_16x16x32_bf16 v[116:119], v[32:35], v[148:151], v[116:119]
    s_waitcnt lgkmcnt(8)
    v_mfma_f32_16x16x32_bf16 v[120:123], v[36:39], v[148:151], v[120:123]
    s_waitcnt lgkmcnt(6)
    v_mfma_f32_16x16x32_bf16 v[124:127], v[40:43], v[148:151], v[124:127]
    s_waitcnt lgkmcnt(4)
    v_mfma_f32_16x16x32_bf16 v[128:131], v[68:71], v[148:151], v[128:131]
    s_waitcnt lgkmcnt(2)
    v_mfma_f32_16x16x32_bf16 v[132:135], v[72:75], v[148:151], v[132:135]
    s_waitcnt lgkmcnt(0)
    v_mfma_f32_16x16x32_bf16 v[136:139], v[76:79], v[148:151], v[136:139]
    v_cvt_pk_bf16_f32 v116, v116, v117
    v_cvt_pk_bf16_f32 v117, v118, v119
    v_cvt_pk_bf16_f32 v118, v120, v121
    v_cvt_pk_bf16_f32 v119, v122, v123
    ds_write_b128 v6, v[116:119] offset:57600
    v_cvt_pk_bf16_f32 v124, v124, v125
    v_cvt_pk_bf16_f32 v125, v126, v127
    ds_write_b64 v7, v[124:125] offset:57664
    v_cvt_pk_bf16_f32 v128, v128, v129
    v_cvt_pk_bf16_f32 v129, v130, v131
    v_cvt_pk_bf16_f32 v130, v132, v133
    v_cvt_pk_bf16_f32 v131, v134, v135
    ds_write_b128 v6, v[128:131] offset:57408
    v_cvt_pk_bf16_f32 v136, v136, v137
    v_cvt_pk_bf16_f32 v137, v138, v139
    ds_write_b64 v7, v[136:137] offset:57472
    s_waitcnt lgkmcnt(0)
    s_barrier
    ds_read_b128 v[152:155], v5 offset:27648
    ds_read_b128 v[140:143], v5 offset:27712
    ds_read_b128 v[144:147], v5 offset:27776
    s_waitcnt lgkmcnt(2)
    v_mfma_f32_16x16x32_bf16 v[116:119], v[8:11], v[152:155], 0
    ds_write_b64 v82, v[80:81]
    v_mfma_f32_16x16x32_bf16 v[120:123], v[12:15], v[152:155], 0
    buffer_load_dwordx4 v[94:97], v1, s[24:27], 0 offen offset:188
    v_mfma_f32_16x16x32_bf16 v[124:127], v[16:19], v[152:155], 0
    buffer_load_dwordx3 v[92:94], v1, s[24:27], 0 offen offset:0
    v_mfma_f32_16x16x32_bf16 v[128:131], v[44:47], v[152:155], 0
    buffer_load_dwordx4 v[100:103], v1, s[24:27], 0 offen offset:572
    v_mfma_f32_16x16x32_bf16 v[132:135], v[48:51], v[152:155], 0
    buffer_load_dwordx3 v[98:100], v1, s[24:27], 0 offen offset:384
    v_mfma_f32_16x16x32_bf16 v[136:139], v[52:55], v[152:155], 0
    buffer_load_dwordx4 v[106:109], v1, s[24:27], 0 offen offset:956
    s_waitcnt lgkmcnt(2)
    v_mfma_f32_16x16x32_bf16 v[116:119], v[20:23], v[140:143], v[116:119]
    buffer_load_dwordx3 v[104:106], v1, s[24:27], 0 offen offset:768
    v_mfma_f32_16x16x32_bf16 v[120:123], v[24:27], v[140:143], v[120:123]
    buffer_load_dwordx4 v[112:115], v1, s[24:27], 0 offen offset:1340
    v_mfma_f32_16x16x32_bf16 v[124:127], v[28:31], v[140:143], v[124:127]
    buffer_load_dwordx3 v[110:112], v1, s[24:27], 0 offen offset:1152
    v_mfma_f32_16x16x32_bf16 v[128:131], v[56:59], v[140:143], v[128:131]
    v_mfma_f32_16x16x32_bf16 v[132:135], v[60:63], v[140:143], v[132:135]
    v_mfma_f32_16x16x32_bf16 v[136:139], v[64:67], v[140:143], v[136:139]
    s_waitcnt lgkmcnt(1)
    v_mfma_f32_16x16x32_bf16 v[116:119], v[32:35], v[144:147], v[116:119]
    v_mfma_f32_16x16x32_bf16 v[120:123], v[36:39], v[144:147], v[120:123]
    v_mfma_f32_16x16x32_bf16 v[124:127], v[40:43], v[144:147], v[124:127]
    v_mfma_f32_16x16x32_bf16 v[128:131], v[68:71], v[144:147], v[128:131]
    v_mfma_f32_16x16x32_bf16 v[132:135], v[72:75], v[144:147], v[132:135]
    v_mfma_f32_16x16x32_bf16 v[136:139], v[76:79], v[144:147], v[136:139]
    s_nop 2
    v_cvt_pk_bf16_f32 v116, v116, v117
    v_cvt_pk_bf16_f32 v117, v118, v119
    v_cvt_pk_bf16_f32 v118, v120, v121
    v_cvt_pk_bf16_f32 v119, v122, v123
    ds_write_b128 v6, v[116:119] offset:25600
    v_cvt_pk_bf16_f32 v124, v124, v125
    v_cvt_pk_bf16_f32 v125, v126, v127
    ds_write_b64 v7, v[124:125] offset:25664
    v_cvt_pk_bf16_f32 v128, v128, v129
    v_cvt_pk_bf16_f32 v129, v130, v131
    v_cvt_pk_bf16_f32 v130, v132, v133
    v_cvt_pk_bf16_f32 v131, v134, v135
    ds_write_b128 v6, v[128:131] offset:25408
    v_cvt_pk_bf16_f32 v136, v136, v137
    v_cvt_pk_bf16_f32 v137, v138, v139
    ds_write_b64 v7, v[136:137] offset:25472
    s_waitcnt lgkmcnt(0)
    s_barrier
    ds_read_b128 v[148:151], v5 offset:30720
    ds_read_b128 v[152:155], v5 offset:30784
    ds_read_b128 v[140:143], v5 offset:30848
    ds_read_b128 v[144:147], v5 offset:33792
    s_waitcnt lgkmcnt(3)
    v_mfma_f32_16x16x32_bf16 v[116:119], v[8:11], v[148:151], 0
    buffer_load_dwordx4 v[70:73], v1, s[24:27], s60 offen offset:188
    buffer_load_dwordx3 v[68:70], v1, s[24:27], s60 offen offset:0
    buffer_load_dwordx4 v[76:79], v1, s[24:27], s60 offen offset:572
    v_mfma_f32_16x16x32_bf16 v[120:123], v[12:15], v[148:151], 0
    buffer_load_dwordx3 v[74:76], v1, s[24:27], s60 offen offset:384
    buffer_load_dwordx4 v[82:85], v1, s[24:27], s60 offen offset:956
    buffer_load_dwordx3 v[80:82], v1, s[24:27], s60 offen offset:768
    v_mfma_f32_16x16x32_bf16 v[124:127], v[16:19], v[148:151], 0
    buffer_load_dwordx4 v[88:91], v1, s[24:27], s60 offen offset:1340
    buffer_load_dwordx3 v[86:88], v1, s[24:27], s60 offen offset:1152
    buffer_load_dwordx4 v[158:161], v1, s[24:27], s59 offen offset:188
    s_waitcnt lgkmcnt(2)
    v_mfma_f32_16x16x32_bf16 v[116:119], v[20:23], v[152:155], v[116:119]
    buffer_load_dwordx3 v[156:158], v1, s[24:27], s59 offen offset:0
    buffer_load_dwordx4 v[164:167], v1, s[24:27], s59 offen offset:572
    buffer_load_dwordx3 v[162:164], v1, s[24:27], s59 offen offset:384
    ds_read_b128 v[148:151], v5 offset:33856
    v_mfma_f32_16x16x32_bf16 v[120:123], v[24:27], v[152:155], v[120:123]
    buffer_load_dwordx4 v[130:133], v1, s[24:27], s59 offen offset:956
    buffer_load_dwordx3 v[128:130], v1, s[24:27], s59 offen offset:768
    buffer_load_dwordx4 v[136:139], v1, s[24:27], s59 offen offset:1340
    v_mfma_f32_16x16x32_bf16 v[124:127], v[28:31], v[152:155], v[124:127]
    buffer_load_dwordx3 v[134:136], v1, s[24:27], s59 offen offset:1152
    s_waitcnt lgkmcnt(2)
    v_mfma_f32_16x16x32_bf16 v[116:119], v[32:35], v[140:143], v[116:119]
    ds_read_b128 v[152:155], v5 offset:33920
    v_mfma_f32_16x16x32_bf16 v[120:123], v[36:39], v[140:143], v[120:123]
    v_mfma_f32_16x16x32_bf16 v[124:127], v[40:43], v[140:143], v[124:127]
    s_nop 4
    v_cvt_pk_bf16_f32 v116, v116, v117
    v_cvt_pk_bf16_f32 v117, v118, v119
    v_cvt_pk_bf16_f32 v118, v120, v121
    v_cvt_pk_bf16_f32 v119, v122, v123
    ds_write_b128 v6, v[116:119] offset:32000
    v_cvt_pk_bf16_f32 v124, v124, v125
    v_cvt_pk_bf16_f32 v125, v126, v127
    ds_write_b64 v7, v[124:125] offset:32064
    s_waitcnt lgkmcnt(4)
    v_mfma_f32_16x16x32_bf16 v[116:119], v[8:11], v[144:147], 0
    s_waitcnt vmcnt(22)
    v_perm_b32 v44, v95, v92, s57
    v_perm_b32 v48, v95, v92, s58
    ds_read_b128 v[140:143], v5 offset:36864
    v_mfma_f32_16x16x32_bf16 v[120:123], v[12:15], v[144:147], 0
    v_perm_b32 v52, v96, v93, s57
    v_perm_b32 v56, v96, v93, s58
    v_mfma_f32_16x16x32_bf16 v[124:127], v[16:19], v[144:147], 0
    v_perm_b32 v60, v97, v94, s57
    v_perm_b32 v64, v97, v94, s58
    s_waitcnt lgkmcnt(4)
    v_mfma_f32_16x16x32_bf16 v[116:119], v[20:23], v[148:151], v[116:119]
    s_waitcnt vmcnt(20)
    v_perm_b32 v45, v101, v98, s57
    v_perm_b32 v49, v101, v98, s58
    ds_read_b128 v[144:147], v5 offset:36928
    v_mfma_f32_16x16x32_bf16 v[120:123], v[24:27], v[148:151], v[120:123]
    v_perm_b32 v53, v102, v99, s57
    v_perm_b32 v57, v102, v99, s58
    v_mfma_f32_16x16x32_bf16 v[124:127], v[28:31], v[148:151], v[124:127]
    v_perm_b32 v61, v103, v100, s57
    v_perm_b32 v65, v103, v100, s58
    s_waitcnt lgkmcnt(4)
    v_mfma_f32_16x16x32_bf16 v[116:119], v[32:35], v[152:155], v[116:119]
    s_waitcnt vmcnt(18)
    v_perm_b32 v46, v107, v104, s57
    v_perm_b32 v50, v107, v104, s58
    ds_read_b128 v[148:151], v5 offset:36992
    v_mfma_f32_16x16x32_bf16 v[120:123], v[36:39], v[152:155], v[120:123]
    v_perm_b32 v54, v108, v105, s57
    v_perm_b32 v58, v108, v105, s58
    v_mfma_f32_16x16x32_bf16 v[124:127], v[40:43], v[152:155], v[124:127]
    v_perm_b32 v62, v109, v106, s57
    v_perm_b32 v66, v109, v106, s58
    v_cvt_pk_bf16_f32 v116, v116, v117
    v_cvt_pk_bf16_f32 v117, v118, v119
    s_nop 0
    v_cvt_pk_bf16_f32 v118, v120, v121
    v_cvt_pk_bf16_f32 v119, v122, v123
    ds_write_b128 v6, v[116:119] offset:38400
    v_cvt_pk_bf16_f32 v124, v124, v125
    v_cvt_pk_bf16_f32 v125, v126, v127
    ds_write_b64 v7, v[124:125] offset:38464
    s_waitcnt lgkmcnt(4)
    v_mfma_f32_16x16x32_bf16 v[116:119], v[8:11], v[140:143], 0
    s_waitcnt vmcnt(16)
    v_perm_b32 v47, v113, v110, s57
    v_perm_b32 v51, v113, v110, s58
    v_perm_b32 v55, v114, v111, s57
    ds_read_b128 v[152:155], v5 offset:39936
    v_mfma_f32_16x16x32_bf16 v[120:123], v[12:15], v[140:143], 0
    v_perm_b32 v59, v114, v111, s58
    v_perm_b32 v63, v115, v112, s57
    v_perm_b32 v67, v115, v112, s58
    v_mfma_f32_16x16x32_bf16 v[124:127], v[16:19], v[140:143], 0
    s_waitcnt vmcnt(14)
    v_perm_b32 v92, v71, v68, s57
    v_perm_b32 v96, v71, v68, s58
    v_perm_b32 v100, v72, v69, s57
    s_waitcnt lgkmcnt(4)
    v_mfma_f32_16x16x32_bf16 v[116:119], v[20:23], v[144:147], v[116:119]
    v_perm_b32 v104, v72, v69, s58
    v_perm_b32 v108, v73, v70, s57
    v_perm_b32 v112, v73, v70, s58
    ds_read_b128 v[140:143], v5 offset:40000
    v_mfma_f32_16x16x32_bf16 v[120:123], v[24:27], v[144:147], v[120:123]
    s_waitcnt vmcnt(12)
    v_perm_b32 v93, v77, v74, s57
    v_perm_b32 v97, v77, v74, s58
    v_perm_b32 v101, v78, v75, s57
    v_mfma_f32_16x16x32_bf16 v[124:127], v[28:31], v[144:147], v[124:127]
    v_perm_b32 v105, v78, v75, s58
    v_perm_b32 v109, v79, v76, s57
    v_perm_b32 v113, v79, v76, s58
    s_waitcnt lgkmcnt(4)
    v_mfma_f32_16x16x32_bf16 v[116:119], v[32:35], v[148:151], v[116:119]
    s_waitcnt vmcnt(10)
    v_perm_b32 v94, v83, v80, s57
    v_perm_b32 v98, v83, v80, s58
    v_perm_b32 v102, v84, v81, s57
    ds_read_b128 v[144:147], v5 offset:40064
    v_mfma_f32_16x16x32_bf16 v[120:123], v[36:39], v[148:151], v[120:123]
    v_perm_b32 v106, v84, v81, s58
    v_perm_b32 v110, v85, v82, s57
    v_perm_b32 v114, v85, v82, s58
    v_mfma_f32_16x16x32_bf16 v[124:127], v[40:43], v[148:151], v[124:127]
    s_waitcnt vmcnt(8)
    v_perm_b32 v95, v89, v86, s57
    v_perm_b32 v99, v89, v86, s58
    v_perm_b32 v103, v90, v87, s57
    ds_read_b128 v[148:151], v5 offset:43008
    v_cvt_pk_bf16_f32 v116, v116, v117
    v_cvt_pk_bf16_f32 v117, v118, v119
    v_cvt_pk_bf16_f32 v118, v120, v121
    v_cvt_pk_bf16_f32 v119, v122, v123
    ds_write_b128 v6, v[116:119] offset:44800
    v_cvt_pk_bf16_f32 v124, v124, v125
    v_cvt_pk_bf16_f32 v125, v126, v127
    ds_write_b64 v7, v[124:125] offset:44864
    v_perm_b32 v107, v90, v87, s58
    v_perm_b32 v111, v91, v88, s57
    v_perm_b32 v115, v91, v88, s58
    s_waitcnt vmcnt(6)
    v_perm_b32 v68, v159, v156, s57
    v_perm_b32 v72, v159, v156, s58
    v_perm_b32 v76, v160, v157, s57
    v_perm_b32 v80, v160, v157, s58
    v_perm_b32 v84, v161, v158, s57
    v_perm_b32 v88, v161, v158, s58
    s_waitcnt vmcnt(4)
    v_perm_b32 v69, v165, v162, s57
    v_perm_b32 v73, v165, v162, s58
    v_perm_b32 v77, v166, v163, s57
    v_perm_b32 v81, v166, v163, s58
    v_perm_b32 v85, v167, v164, s57
    v_perm_b32 v89, v167, v164, s58
    s_waitcnt vmcnt(2)
    v_perm_b32 v70, v131, v128, s57
    v_perm_b32 v74, v131, v128, s58
    v_perm_b32 v78, v132, v129, s57
    v_perm_b32 v82, v132, v129, s58
    v_perm_b32 v86, v133, v130, s57
    v_perm_b32 v90, v133, v130, s58
    s_waitcnt vmcnt(0)
    v_perm_b32 v71, v137, v134, s57
    v_perm_b32 v75, v137, v134, s58
    v_perm_b32 v79, v138, v135, s57
    v_perm_b32 v83, v138, v135, s58
    v_perm_b32 v87, v139, v136, s57
    v_perm_b32 v91, v139, v136, s58
    s_waitcnt lgkmcnt(0)
    s_barrier
    v_mfma_f32_16x16x32_bf16 v[156:159], v[8:11], v[152:155], 0
    v_mfma_f32_16x16x32_bf16 v[160:163], v[12:15], v[152:155], 0
    v_mfma_f32_16x16x32_bf16 v[164:167], v[16:19], v[152:155], 0
    v_mfma_f32_16x16x32_bf16 v[156:159], v[20:23], v[140:143], v[156:159]
    ds_read_b128 v[152:155], v5 offset:43072
    v_mfma_f32_16x16x32_bf16 v[160:163], v[24:27], v[140:143], v[160:163]
    v_mfma_f32_16x16x32_bf16 v[164:167], v[28:31], v[140:143], v[164:167]
    v_mfma_f32_16x16x32_bf16 v[156:159], v[32:35], v[144:147], v[156:159]
    ds_read_b128 v[140:143], v5 offset:43136
    v_mfma_f32_16x16x32_bf16 v[160:163], v[36:39], v[144:147], v[160:163]
    v_mfma_f32_16x16x32_bf16 v[164:167], v[40:43], v[144:147], v[164:167]
    v_mfma_f32_16x16x32_bf16 v[116:119], v[8:11], v[148:151], 0
    v_add_u32 v5, 46080, v5
    ds_read_b128 v[144:147], v5 offset:0
    v_mfma_f32_16x16x32_bf16 v[120:123], v[12:15], v[148:151], 0
    s_nop 0
    v_cvt_pk_bf16_f32 v156, v156, v157
    v_mfma_f32_16x16x32_bf16 v[124:127], v[16:19], v[148:151], 0
    v_cvt_pk_bf16_f32 v157, v158, v159
    s_waitcnt lgkmcnt(2)
    v_mfma_f32_16x16x32_bf16 v[116:119], v[20:23], v[152:155], v[116:119]
    v_cvt_pk_bf16_f32 v158, v160, v161
    ds_read_b128 v[148:151], v5 offset:64
    v_mfma_f32_16x16x32_bf16 v[120:123], v[24:27], v[152:155], v[120:123]
    v_cvt_pk_bf16_f32 v159, v162, v163
    v_mfma_f32_16x16x32_bf16 v[124:127], v[28:31], v[152:155], v[124:127]
    ds_write_b128 v6, v[156:159] offset:51200
    s_waitcnt lgkmcnt(3)
    v_mfma_f32_16x16x32_bf16 v[116:119], v[32:35], v[140:143], v[116:119]
    v_cvt_pk_bf16_f32 v164, v164, v165
    ds_read_b128 v[152:155], v5 offset:128
    v_mfma_f32_16x16x32_bf16 v[120:123], v[36:39], v[140:143], v[120:123]
    v_cvt_pk_bf16_f32 v165, v166, v167
    v_mfma_f32_16x16x32_bf16 v[124:127], v[40:43], v[140:143], v[124:127]
    ds_write_b64 v7, v[164:165] offset:51264
    s_waitcnt lgkmcnt(4)
    v_mfma_f32_16x16x32_bf16 v[156:159], v[8:11], v[144:147], 0
    ds_read_b128 v[140:143], v3 offset:12288
    v_mfma_f32_16x16x32_bf16 v[160:163], v[12:15], v[144:147], 0
    v_cvt_pk_bf16_f32 v116, v116, v117
    v_mfma_f32_16x16x32_bf16 v[164:167], v[16:19], v[144:147], 0
    v_cvt_pk_bf16_f32 v117, v118, v119
    s_waitcnt lgkmcnt(4)
    v_mfma_f32_16x16x32_bf16 v[156:159], v[20:23], v[148:151], v[156:159]
    v_cvt_pk_bf16_f32 v118, v120, v121
    ds_read_b128 v[144:147], v3 offset:13312
    v_mfma_f32_16x16x32_bf16 v[160:163], v[24:27], v[148:151], v[160:163]
    v_cvt_pk_bf16_f32 v119, v122, v123
    v_mfma_f32_16x16x32_bf16 v[164:167], v[28:31], v[148:151], v[164:167]
    ds_write_b128 v6, v[116:119] offset:57600
    s_waitcnt lgkmcnt(4)
    v_mfma_f32_16x16x32_bf16 v[156:159], v[32:35], v[152:155], v[156:159]
    v_cvt_pk_bf16_f32 v124, v124, v125
    ds_read_b128 v[148:151], v3 offset:14336
    v_mfma_f32_16x16x32_bf16 v[160:163], v[36:39], v[152:155], v[160:163]
    v_cvt_pk_bf16_f32 v125, v126, v127
    v_mfma_f32_16x16x32_bf16 v[164:167], v[40:43], v[152:155], v[164:167]
    ds_write_b64 v7, v[124:125] offset:57664
    s_waitcnt lgkmcnt(4)
    v_mfma_f32_16x16x32_bf16 v[116:119], v[140:143], v[44:47], 0
    ds_read_b128 v[152:155], v5 offset:3072
    v_mfma_f32_16x16x32_bf16 v[120:123], v[140:143], v[48:51], 0
    v_mfma_f32_16x16x32_bf16 v[124:127], v[140:143], v[52:55], 0
    v_cvt_pk_bf16_f32 v156, v156, v157
    v_mfma_f32_16x16x32_bf16 v[128:131], v[140:143], v[56:59], 0
    v_mfma_f32_16x16x32_bf16 v[132:135], v[140:143], v[60:63], 0
    v_cvt_pk_bf16_f32 v157, v158, v159
    v_mfma_f32_16x16x32_bf16 v[136:139], v[140:143], v[64:67], 0
    s_waitcnt lgkmcnt(4)
    v_mfma_f32_16x16x32_bf16 v[116:119], v[144:147], v[68:71], v[116:119]
    v_cvt_pk_bf16_f32 v158, v160, v161
    ds_read_b128 v[140:143], v5 offset:3136
    v_mfma_f32_16x16x32_bf16 v[120:123], v[144:147], v[72:75], v[120:123]
    v_mfma_f32_16x16x32_bf16 v[124:127], v[144:147], v[76:79], v[124:127]
    v_cvt_pk_bf16_f32 v159, v162, v163
    v_mfma_f32_16x16x32_bf16 v[128:131], v[144:147], v[80:83], v[128:131]
    v_mfma_f32_16x16x32_bf16 v[132:135], v[144:147], v[84:87], v[132:135]
    v_mfma_f32_16x16x32_bf16 v[136:139], v[144:147], v[88:91], v[136:139]
    ds_write_b128 v6, v[156:159] offset:0
    s_waitcnt lgkmcnt(4)
    v_mfma_f32_16x16x32_bf16 v[116:119], v[148:151], v[92:95], v[116:119]
    ds_read_b128 v[144:147], v5 offset:3200
    v_mfma_f32_16x16x32_bf16 v[120:123], v[148:151], v[96:99], v[120:123]
    v_cvt_pk_bf16_f32 v164, v164, v165
    v_mfma_f32_16x16x32_bf16 v[124:127], v[148:151], v[100:103], v[124:127]
    v_mfma_f32_16x16x32_bf16 v[128:131], v[148:151], v[104:107], v[128:131]
    v_cvt_pk_bf16_f32 v165, v166, v167
    v_mfma_f32_16x16x32_bf16 v[132:135], v[148:151], v[108:111], v[132:135]
    v_mfma_f32_16x16x32_bf16 v[136:139], v[148:151], v[112:115], v[136:139]
    ds_write_b64 v7, v[164:165] offset:64
    ds_read_b128 v[148:151], v5 offset:6144
    s_mul_i32 s61, s41, 0
    s_ashr_i32 s61, s61, 1
    s_add_u32 s61, s61, s43
    v_cmp_class_f32 vcc, v116, s56
    v_cvt_pk_bf16_f32 v0, v116, v120
    v_cvt_pk_bf16_f32 v1, v124, v128
    v_cvt_pk_bf16_f32 v2, v132, v136
    s_or_b64 s[46:47], s[46:47], vcc
    buffer_store_dwordx3 v[0:2], v4, s[32:35], s61 offen offset:0 sc0 sc1
    v_cmp_class_f32 vcc, v117, s56
    s_nop 0
    v_cvt_pk_bf16_f32 v0, v117, v121
    v_cvt_pk_bf16_f32 v1, v125, v129
    v_cvt_pk_bf16_f32 v2, v133, v137
    s_or_b64 s[46:47], s[46:47], vcc
    buffer_store_dwordx3 v[0:2], v4, s[32:35], s61 offen offset:384 sc0 sc1
    v_cmp_class_f32 vcc, v118, s56
    v_cvt_pk_bf16_f32 v116, v118, v122
    v_cvt_pk_bf16_f32 v117, v126, v130
    v_cvt_pk_bf16_f32 v118, v134, v138
    s_or_b64 s[46:47], s[46:47], vcc
    buffer_store_dwordx3 v[116:118], v4, s[32:35], s61 offen offset:768 sc0 sc1
    v_cmp_class_f32 vcc, v119, s56
    v_cvt_pk_bf16_f32 v120, v119, v123
    v_cvt_pk_bf16_f32 v121, v127, v131
    v_cvt_pk_bf16_f32 v122, v135, v139
    s_or_b64 s[46:47], s[46:47], vcc
    s_mov_b64 exec, s[44:45]
    buffer_store_dwordx3 v[120:122], v4, s[32:35], s61 offen offset:1152 sc0 sc1
    s_mov_b64 exec, -1
    s_waitcnt lgkmcnt(0)
    s_barrier
    v_mfma_f32_16x16x32_bf16 v[156:159], v[8:11], v[152:155], 0
    v_mfma_f32_16x16x32_bf16 v[160:163], v[12:15], v[152:155], 0
    v_mfma_f32_16x16x32_bf16 v[164:167], v[16:19], v[152:155], 0
    v_mfma_f32_16x16x32_bf16 v[156:159], v[20:23], v[140:143], v[156:159]
    ds_read_b128 v[152:155], v5 offset:6208
    v_mfma_f32_16x16x32_bf16 v[160:163], v[24:27], v[140:143], v[160:163]
    v_mfma_f32_16x16x32_bf16 v[164:167], v[28:31], v[140:143], v[164:167]
    v_mfma_f32_16x16x32_bf16 v[156:159], v[32:35], v[144:147], v[156:159]
    ds_read_b128 v[140:143], v5 offset:6272
    v_mfma_f32_16x16x32_bf16 v[160:163], v[36:39], v[144:147], v[160:163]
    v_mfma_f32_16x16x32_bf16 v[164:167], v[40:43], v[144:147], v[164:167]
    v_mfma_f32_16x16x32_bf16 v[116:119], v[8:11], v[148:151], 0
    ds_read_b128 v[144:147], v5 offset:9216
    v_mfma_f32_16x16x32_bf16 v[120:123], v[12:15], v[148:151], 0
    s_nop 1
    v_cvt_pk_bf16_f32 v156, v156, v157
    v_mfma_f32_16x16x32_bf16 v[124:127], v[16:19], v[148:151], 0
    v_cvt_pk_bf16_f32 v157, v158, v159
    s_waitcnt lgkmcnt(2)
    v_mfma_f32_16x16x32_bf16 v[116:119], v[20:23], v[152:155], v[116:119]
    v_cvt_pk_bf16_f32 v158, v160, v161
    ds_read_b128 v[148:151], v5 offset:9280
    v_mfma_f32_16x16x32_bf16 v[120:123], v[24:27], v[152:155], v[120:123]
    v_cvt_pk_bf16_f32 v159, v162, v163
    v_mfma_f32_16x16x32_bf16 v[124:127], v[28:31], v[152:155], v[124:127]
    ds_write_b128 v6, v[156:159] offset:6400
    s_waitcnt lgkmcnt(3)
    v_mfma_f32_16x16x32_bf16 v[116:119], v[32:35], v[140:143], v[116:119]
    v_cvt_pk_bf16_f32 v164, v164, v165
    ds_read_b128 v[152:155], v5 offset:9344
    v_mfma_f32_16x16x32_bf16 v[120:123], v[36:39], v[140:143], v[120:123]
    v_cvt_pk_bf16_f32 v165, v166, v167
    v_mfma_f32_16x16x32_bf16 v[124:127], v[40:43], v[140:143], v[124:127]
    ds_write_b64 v7, v[164:165] offset:6464
    s_waitcnt lgkmcnt(4)
    v_mfma_f32_16x16x32_bf16 v[156:159], v[8:11], v[144:147], 0
    ds_read_b128 v[140:143], v3 offset:0
    v_mfma_f32_16x16x32_bf16 v[160:163], v[12:15], v[144:147], 0
    v_cvt_pk_bf16_f32 v116, v116, v117
    v_mfma_f32_16x16x32_bf16 v[164:167], v[16:19], v[144:147], 0
    v_cvt_pk_bf16_f32 v117, v118, v119
    s_waitcnt lgkmcnt(4)
    v_mfma_f32_16x16x32_bf16 v[156:159], v[20:23], v[148:151], v[156:159]
    v_cvt_pk_bf16_f32 v118, v120, v121
    ds_read_b128 v[144:147], v3 offset:1024
    v_mfma_f32_16x16x32_bf16 v[160:163], v[24:27], v[148:151], v[160:163]
    v_cvt_pk_bf16_f32 v119, v122, v123
    v_mfma_f32_16x16x32_bf16 v[164:167], v[28:31], v[148:151], v[164:167]
    ds_write_b128 v6, v[116:119] offset:12800
    s_waitcnt lgkmcnt(4)
    v_mfma_f32_16x16x32_bf16 v[156:159], v[32:35], v[152:155], v[156:159]
    v_cvt_pk_bf16_f32 v124, v124, v125
    ds_read_b128 v[148:151], v3 offset:2048
    v_mfma_f32_16x16x32_bf16 v[160:163], v[36:39], v[152:155], v[160:163]
    v_cvt_pk_bf16_f32 v125, v126, v127
    v_mfma_f32_16x16x32_bf16 v[164:167], v[40:43], v[152:155], v[164:167]
    ds_write_b64 v7, v[124:125] offset:12864
    s_waitcnt lgkmcnt(4)
    v_mfma_f32_16x16x32_bf16 v[116:119], v[140:143], v[44:47], 0
    ds_read_b128 v[152:155], v5 offset:12288
    v_mfma_f32_16x16x32_bf16 v[120:123], v[140:143], v[48:51], 0
    v_mfma_f32_16x16x32_bf16 v[124:127], v[140:143], v[52:55], 0
    v_cvt_pk_bf16_f32 v156, v156, v157
    v_mfma_f32_16x16x32_bf16 v[128:131], v[140:143], v[56:59], 0
    v_mfma_f32_16x16x32_bf16 v[132:135], v[140:143], v[60:63], 0
    v_cvt_pk_bf16_f32 v157, v158, v159
    v_mfma_f32_16x16x32_bf16 v[136:139], v[140:143], v[64:67], 0
    s_waitcnt lgkmcnt(4)
    v_mfma_f32_16x16x32_bf16 v[116:119], v[144:147], v[68:71], v[116:119]
    v_cvt_pk_bf16_f32 v158, v160, v161
    ds_read_b128 v[140:143], v5 offset:12352
    v_mfma_f32_16x16x32_bf16 v[120:123], v[144:147], v[72:75], v[120:123]
    v_mfma_f32_16x16x32_bf16 v[124:127], v[144:147], v[76:79], v[124:127]
    v_cvt_pk_bf16_f32 v159, v162, v163
    v_mfma_f32_16x16x32_bf16 v[128:131], v[144:147], v[80:83], v[128:131]
    v_mfma_f32_16x16x32_bf16 v[132:135], v[144:147], v[84:87], v[132:135]
    v_mfma_f32_16x16x32_bf16 v[136:139], v[144:147], v[88:91], v[136:139]
    ds_write_b128 v6, v[156:159] offset:19200
    s_waitcnt lgkmcnt(4)
    v_mfma_f32_16x16x32_bf16 v[116:119], v[148:151], v[92:95], v[116:119]
    ds_read_b128 v[144:147], v5 offset:12416
    v_mfma_f32_16x16x32_bf16 v[120:123], v[148:151], v[96:99], v[120:123]
    v_cvt_pk_bf16_f32 v164, v164, v165
    v_mfma_f32_16x16x32_bf16 v[124:127], v[148:151], v[100:103], v[124:127]
    v_mfma_f32_16x16x32_bf16 v[128:131], v[148:151], v[104:107], v[128:131]
    v_cvt_pk_bf16_f32 v165, v166, v167
    v_mfma_f32_16x16x32_bf16 v[132:135], v[148:151], v[108:111], v[132:135]
    v_mfma_f32_16x16x32_bf16 v[136:139], v[148:151], v[112:115], v[136:139]
    ds_write_b64 v7, v[164:165] offset:19264
    s_mul_i32 s61, s41, 1
    s_ashr_i32 s61, s61, 1
    s_add_u32 s61, s61, s43
    v_cmp_class_f32 vcc, v116, s56
    v_cvt_pk_bf16_f32 v0, v116, v120
    v_cvt_pk_bf16_f32 v1, v124, v128
    s_nop 0
    v_cvt_pk_bf16_f32 v2, v132, v136
    s_or_b64 s[46:47], s[46:47], vcc
    buffer_store_dwordx3 v[0:2], v4, s[32:35], s61 offen offset:0 sc0 sc1
    v_cmp_class_f32 vcc, v117, s56
    s_nop 0
    v_cvt_pk_bf16_f32 v0, v117, v121
    v_cvt_pk_bf16_f32 v1, v125, v129
    v_cvt_pk_bf16_f32 v2, v133, v137
    s_or_b64 s[46:47], s[46:47], vcc
    buffer_store_dwordx3 v[0:2], v4, s[32:35], s61 offen offset:384 sc0 sc1
    v_cmp_class_f32 vcc, v118, s56
    v_cvt_pk_bf16_f32 v116, v118, v122
    v_cvt_pk_bf16_f32 v117, v126, v130
    v_cvt_pk_bf16_f32 v118, v134, v138
    s_or_b64 s[46:47], s[46:47], vcc
    buffer_store_dwordx3 v[116:118], v4, s[32:35], s61 offen offset:768 sc0 sc1
    v_cmp_class_f32 vcc, v119, s56
    v_cvt_pk_bf16_f32 v120, v119, v123
    v_cvt_pk_bf16_f32 v121, v127, v131
    v_cvt_pk_bf16_f32 v122, v135, v139
    s_or_b64 s[46:47], s[46:47], vcc
    s_mov_b64 exec, s[44:45]
    buffer_store_dwordx3 v[120:122], v4, s[32:35], s61 offen offset:1152 sc0 sc1
    s_mov_b64 exec, -1
    s_waitcnt lgkmcnt(0)
    s_barrier
    ds_read_b128 v[148:151], v5 offset:15360
    v_mfma_f32_16x16x32_bf16 v[156:159], v[8:11], v[152:155], 0
    v_mfma_f32_16x16x32_bf16 v[160:163], v[12:15], v[152:155], 0
    v_mfma_f32_16x16x32_bf16 v[164:167], v[16:19], v[152:155], 0
    v_mfma_f32_16x16x32_bf16 v[156:159], v[20:23], v[140:143], v[156:159]
    ds_read_b128 v[152:155], v5 offset:15424
    v_mfma_f32_16x16x32_bf16 v[160:163], v[24:27], v[140:143], v[160:163]
    v_mfma_f32_16x16x32_bf16 v[164:167], v[28:31], v[140:143], v[164:167]
    v_mfma_f32_16x16x32_bf16 v[156:159], v[32:35], v[144:147], v[156:159]
    ds_read_b128 v[140:143], v5 offset:15488
    v_mfma_f32_16x16x32_bf16 v[160:163], v[36:39], v[144:147], v[160:163]
    v_mfma_f32_16x16x32_bf16 v[164:167], v[40:43], v[144:147], v[164:167]
    s_waitcnt lgkmcnt(2)
    v_mfma_f32_16x16x32_bf16 v[116:119], v[8:11], v[148:151], 0
    ds_read_b128 v[144:147], v5 offset:18432
    v_mfma_f32_16x16x32_bf16 v[120:123], v[12:15], v[148:151], 0
    s_nop 0
    v_cvt_pk_bf16_f32 v156, v156, v157
    v_mfma_f32_16x16x32_bf16 v[124:127], v[16:19], v[148:151], 0
    v_cvt_pk_bf16_f32 v157, v158, v159
    s_waitcnt lgkmcnt(2)
    v_mfma_f32_16x16x32_bf16 v[116:119], v[20:23], v[152:155], v[116:119]
    v_cvt_pk_bf16_f32 v158, v160, v161
    ds_read_b128 v[148:151], v5 offset:18496
    v_mfma_f32_16x16x32_bf16 v[120:123], v[24:27], v[152:155], v[120:123]
    v_cvt_pk_bf16_f32 v159, v162, v163
    v_mfma_f32_16x16x32_bf16 v[124:127], v[28:31], v[152:155], v[124:127]
    ds_write_b128 v6, v[156:159] offset:25600
    s_waitcnt lgkmcnt(3)
    v_mfma_f32_16x16x32_bf16 v[116:119], v[32:35], v[140:143], v[116:119]
    v_cvt_pk_bf16_f32 v164, v164, v165
    ds_read_b128 v[152:155], v5 offset:18560
    v_mfma_f32_16x16x32_bf16 v[120:123], v[36:39], v[140:143], v[120:123]
    v_cvt_pk_bf16_f32 v165, v166, v167
    v_mfma_f32_16x16x32_bf16 v[124:127], v[40:43], v[140:143], v[124:127]
    ds_write_b64 v7, v[164:165] offset:25664
    s_waitcnt lgkmcnt(4)
    v_mfma_f32_16x16x32_bf16 v[156:159], v[8:11], v[144:147], 0
    ds_read_b128 v[140:143], v3 offset:6144
    v_mfma_f32_16x16x32_bf16 v[160:163], v[12:15], v[144:147], 0
    v_cvt_pk_bf16_f32 v116, v116, v117
    v_mfma_f32_16x16x32_bf16 v[164:167], v[16:19], v[144:147], 0
    v_cvt_pk_bf16_f32 v117, v118, v119
    s_waitcnt lgkmcnt(4)
    v_mfma_f32_16x16x32_bf16 v[156:159], v[20:23], v[148:151], v[156:159]
    v_cvt_pk_bf16_f32 v118, v120, v121
    ds_read_b128 v[144:147], v3 offset:7168
    v_mfma_f32_16x16x32_bf16 v[160:163], v[24:27], v[148:151], v[160:163]
    v_cvt_pk_bf16_f32 v119, v122, v123
    v_mfma_f32_16x16x32_bf16 v[164:167], v[28:31], v[148:151], v[164:167]
    ds_write_b128 v6, v[116:119] offset:32000
    s_waitcnt lgkmcnt(4)
    v_mfma_f32_16x16x32_bf16 v[156:159], v[32:35], v[152:155], v[156:159]
    v_cvt_pk_bf16_f32 v124, v124, v125
    ds_read_b128 v[148:151], v3 offset:8192
    v_mfma_f32_16x16x32_bf16 v[160:163], v[36:39], v[152:155], v[160:163]
    v_cvt_pk_bf16_f32 v125, v126, v127
    v_mfma_f32_16x16x32_bf16 v[164:167], v[40:43], v[152:155], v[164:167]
    ds_write_b64 v7, v[124:125] offset:32064
    s_waitcnt lgkmcnt(4)
    v_mfma_f32_16x16x32_bf16 v[116:119], v[140:143], v[44:47], 0
    ds_read_b128 v[152:155], v5 offset:21504
    v_mfma_f32_16x16x32_bf16 v[120:123], v[140:143], v[48:51], 0
    v_mfma_f32_16x16x32_bf16 v[124:127], v[140:143], v[52:55], 0
    v_cvt_pk_bf16_f32 v156, v156, v157
    v_mfma_f32_16x16x32_bf16 v[128:131], v[140:143], v[56:59], 0
    v_mfma_f32_16x16x32_bf16 v[132:135], v[140:143], v[60:63], 0
    v_cvt_pk_bf16_f32 v157, v158, v159
    v_mfma_f32_16x16x32_bf16 v[136:139], v[140:143], v[64:67], 0
    s_waitcnt lgkmcnt(4)
    v_mfma_f32_16x16x32_bf16 v[116:119], v[144:147], v[68:71], v[116:119]
    v_cvt_pk_bf16_f32 v158, v160, v161
    ds_read_b128 v[140:143], v5 offset:21568
    v_mfma_f32_16x16x32_bf16 v[120:123], v[144:147], v[72:75], v[120:123]
    v_mfma_f32_16x16x32_bf16 v[124:127], v[144:147], v[76:79], v[124:127]
    v_cvt_pk_bf16_f32 v159, v162, v163
    v_mfma_f32_16x16x32_bf16 v[128:131], v[144:147], v[80:83], v[128:131]
    v_mfma_f32_16x16x32_bf16 v[132:135], v[144:147], v[84:87], v[132:135]
    v_mfma_f32_16x16x32_bf16 v[136:139], v[144:147], v[88:91], v[136:139]
    ds_write_b128 v6, v[156:159] offset:38400
    s_waitcnt lgkmcnt(4)
    v_mfma_f32_16x16x32_bf16 v[116:119], v[148:151], v[92:95], v[116:119]
    ds_read_b128 v[144:147], v5 offset:21632
    v_mfma_f32_16x16x32_bf16 v[120:123], v[148:151], v[96:99], v[120:123]
    v_cvt_pk_bf16_f32 v164, v164, v165
    v_mfma_f32_16x16x32_bf16 v[124:127], v[148:151], v[100:103], v[124:127]
    v_mfma_f32_16x16x32_bf16 v[128:131], v[148:151], v[104:107], v[128:131]
    v_cvt_pk_bf16_f32 v165, v166, v167
    v_mfma_f32_16x16x32_bf16 v[132:135], v[148:151], v[108:111], v[132:135]
    v_mfma_f32_16x16x32_bf16 v[136:139], v[148:151], v[112:115], v[136:139]
    ds_write_b64 v7, v[164:165] offset:38464
    ds_read_b128 v[148:151], v5 offset:24576
    s_mul_i32 s61, s41, 2
    s_ashr_i32 s61, s61, 1
    s_add_u32 s61, s61, s43
    v_cmp_class_f32 vcc, v116, s56
    v_cvt_pk_bf16_f32 v0, v116, v120
    v_cvt_pk_bf16_f32 v1, v124, v128
    v_cvt_pk_bf16_f32 v2, v132, v136
    s_or_b64 s[46:47], s[46:47], vcc
    buffer_store_dwordx3 v[0:2], v4, s[32:35], s61 offen offset:0 sc0 sc1
    v_cmp_class_f32 vcc, v117, s56
    s_nop 0
    v_cvt_pk_bf16_f32 v0, v117, v121
    v_cvt_pk_bf16_f32 v1, v125, v129
    v_cvt_pk_bf16_f32 v2, v133, v137
    s_or_b64 s[46:47], s[46:47], vcc
    buffer_store_dwordx3 v[0:2], v4, s[32:35], s61 offen offset:384 sc0 sc1
    v_cmp_class_f32 vcc, v118, s56
    v_cvt_pk_bf16_f32 v116, v118, v122
    v_cvt_pk_bf16_f32 v117, v126, v130
    v_cvt_pk_bf16_f32 v118, v134, v138
    s_or_b64 s[46:47], s[46:47], vcc
    buffer_store_dwordx3 v[116:118], v4, s[32:35], s61 offen offset:768 sc0 sc1
    v_cmp_class_f32 vcc, v119, s56
    v_cvt_pk_bf16_f32 v120, v119, v123
    v_cvt_pk_bf16_f32 v121, v127, v131
    v_cvt_pk_bf16_f32 v122, v135, v139
    s_or_b64 s[46:47], s[46:47], vcc
    s_mov_b64 exec, s[44:45]
    buffer_store_dwordx3 v[120:122], v4, s[32:35], s61 offen offset:1152 sc0 sc1
    s_mov_b64 exec, -1
    s_waitcnt lgkmcnt(0)
    s_barrier
    s_sub_u32 s62, s6, 1
    s_cmp_ge_u32 s62, 6
    s_cbranch_scc1 L_edgeo
    v_mfma_f32_16x16x32_bf16 v[156:159], v[8:11], v[152:155], 0
    v_mfma_f32_16x16x32_bf16 v[160:163], v[12:15], v[152:155], 0
    v_mfma_f32_16x16x32_bf16 v[164:167], v[16:19], v[152:155], 0
    v_mfma_f32_16x16x32_bf16 v[156:159], v[20:23], v[140:143], v[156:159]
    ds_read_b128 v[152:155], v5 offset:24640
    v_mfma_f32_16x16x32_bf16 v[160:163], v[24:27], v[140:143], v[160:163]
    v_mfma_f32_16x16x32_bf16 v[164:167], v[28:31], v[140:143], v[164:167]
    v_mfma_f32_16x16x32_bf16 v[156:159], v[32:35], v[144:147], v[156:159]
    ds_read_b128 v[140:143], v5 offset:24704
    v_mfma_f32_16x16x32_bf16 v[160:163], v[36:39], v[144:147], v[160:163]
    v_mfma_f32_16x16x32_bf16 v[164:167], v[40:43], v[144:147], v[164:167]
    v_mfma_f32_16x16x32_bf16 v[116:119], v[8:11], v[148:151], 0
    ds_read_b128 v[144:147], v5 offset:27648
    v_mfma_f32_16x16x32_bf16 v[120:123], v[12:15], v[148:151], 0
    s_nop 1
    v_cvt_pk_bf16_f32 v156, v156, v157
    v_mfma_f32_16x16x32_bf16 v[124:127], v[16:19], v[148:151], 0
    v_cvt_pk_bf16_f32 v157, v158, v159
    s_waitcnt lgkmcnt(2)
    v_mfma_f32_16x16x32_bf16 v[116:119], v[20:23], v[152:155], v[116:119]
    v_cvt_pk_bf16_f32 v158, v160, v161
    ds_read_b128 v[148:151], v5 offset:27712
    v_mfma_f32_16x16x32_bf16 v[120:123], v[24:27], v[152:155], v[120:123]
    v_cvt_pk_bf16_f32 v159, v162, v163
    v_mfma_f32_16x16x32_bf16 v[124:127], v[28:31], v[152:155], v[124:127]
    ds_write_b128 v6, v[156:159] offset:44800
    s_waitcnt lgkmcnt(3)
    v_mfma_f32_16x16x32_bf16 v[116:119], v[32:35], v[140:143], v[116:119]
    v_cvt_pk_bf16_f32 v164, v164, v165
    ds_read_b128 v[152:155], v5 offset:27776
    v_mfma_f32_16x16x32_bf16 v[120:123], v[36:39], v[140:143], v[120:123]
    v_cvt_pk_bf16_f32 v165, v166, v167
    v_mfma_f32_16x16x32_bf16 v[124:127], v[40:43], v[140:143], v[124:127]
    ds_write_b64 v7, v[164:165] offset:44864
    s_waitcnt lgkmcnt(4)
    v_mfma_f32_16x16x32_bf16 v[156:159], v[8:11], v[144:147], 0
    ds_read_b128 v[140:143], v3 offset:12288
    v_mfma_f32_16x16x32_bf16 v[160:163], v[12:15], v[144:147], 0
    v_cvt_pk_bf16_f32 v116, v116, v117
    v_mfma_f32_16x16x32_bf16 v[164:167], v[16:19], v[144:147], 0
    v_cvt_pk_bf16_f32 v117, v118, v119
    s_waitcnt lgkmcnt(4)
    v_mfma_f32_16x16x32_bf16 v[156:159], v[20:23], v[148:151], v[156:159]
    v_cvt_pk_bf16_f32 v118, v120, v121
    ds_read_b128 v[144:147], v3 offset:13312
    v_mfma_f32_16x16x32_bf16 v[160:163], v[24:27], v[148:151], v[160:163]
    v_cvt_pk_bf16_f32 v119, v122, v123
    v_mfma_f32_16x16x32_bf16 v[164:167], v[28:31], v[148:151], v[164:167]
    ds_write_b128 v6, v[116:119] offset:51200
    s_waitcnt lgkmcnt(4)
    v_mfma_f32_16x16x32_bf16 v[156:159], v[32:35], v[152:155], v[156:159]
    v_cvt_pk_bf16_f32 v124, v124, v125
    ds_read_b128 v[148:151], v3 offset:14336
    v_mfma_f32_16x16x32_bf16 v[160:163], v[36:39], v[152:155], v[160:163]
    v_cvt_pk_bf16_f32 v125, v126, v127
    v_mfma_f32_16x16x32_bf16 v[164:167], v[40:43], v[152:155], v[164:167]
    ds_write_b64 v7, v[124:125] offset:51264
    s_waitcnt lgkmcnt(4)
    v_mfma_f32_16x16x32_bf16 v[116:119], v[140:143], v[44:47], 0
    v_mfma_f32_16x16x32_bf16 v[120:123], v[140:143], v[48:51], 0
    v_mfma_f32_16x16x32_bf16 v[124:127], v[140:143], v[52:55], 0
    v_cvt_pk_bf16_f32 v156, v156, v157
    v_mfma_f32_16x16x32_bf16 v[128:131], v[140:143], v[56:59], 0
    v_mfma_f32_16x16x32_bf16 v[132:135], v[140:143], v[60:63], 0
    v_cvt_pk_bf16_f32 v157, v158, v159
    v_mfma_f32_16x16x32_bf16 v[136:139], v[140:143], v[64:67], 0
    s_waitcnt lgkmcnt(3)
    v_mfma_f32_16x16x32_bf16 v[116:119], v[144:147], v[68:71], v[116:119]
    v_cvt_pk_bf16_f32 v158, v160, v161
    v_mfma_f32_16x16x32_bf16 v[120:123], v[144:147], v[72:75], v[120:123]
    v_mfma_f32_16x16x32_bf16 v[124:127], v[144:147], v[76:79], v[124:127]
    v_cvt_pk_bf16_f32 v159, v162, v163
    v_mfma_f32_16x16x32_bf16 v[128:131], v[144:147], v[80:83], v[128:131]
    v_mfma_f32_16x16x32_bf16 v[132:135], v[144:147], v[84:87], v[132:135]
    v_mfma_f32_16x16x32_bf16 v[136:139], v[144:147], v[88:91], v[136:139]
    ds_write_b128 v6, v[156:159] offset:57600
    s_waitcnt lgkmcnt(2)
    v_mfma_f32_16x16x32_bf16 v[116:119], v[148:151], v[92:95], v[116:119]
    v_mfma_f32_16x16x32_bf16 v[120:123], v[148:151], v[96:99], v[120:123]
    v_cvt_pk_bf16_f32 v164, v164, v165
    v_mfma_f32_16x16x32_bf16 v[124:127], v[148:151], v[100:103], v[124:127]
    v_mfma_f32_16x16x32_bf16 v[128:131], v[148:151], v[104:107], v[128:131]
    v_cvt_pk_bf16_f32 v165, v166, v167
    v_mfma_f32_16x16x32_bf16 v[132:135], v[148:151], v[108:111], v[132:135]
    v_mfma_f32_16x16x32_bf16 v[136:139], v[148:151], v[112:115], v[136:139]
    ds_write_b64 v7, v[164:165] offset:57664
    s_mul_i32 s61, s41, 3
    s_ashr_i32 s61, s61, 1
    s_add_u32 s61, s61, s43
    v_cmp_class_f32 vcc, v116, s56
    v_cvt_pk_bf16_f32 v0, v116, v120
    v_cvt_pk_bf16_f32 v1, v124, v128
    s_nop 0
    v_cvt_pk_bf16_f32 v2, v132, v136
    s_or_b64 s[46:47], s[46:47], vcc
    buffer_store_dwordx3 v[0:2], v4, s[32:35], s61 offen offset:0 sc0 sc1
    v_cmp_class_f32 vcc, v117, s56
    s_nop 0
    v_cvt_pk_bf16_f32 v0, v117, v121
    v_cvt_pk_bf16_f32 v1, v125, v129
    v_cvt_pk_bf16_f32 v2, v133, v137
    s_or_b64 s[46:47], s[46:47], vcc
    buffer_store_dwordx3 v[0:2], v4, s[32:35], s61 offen offset:384 sc0 sc1
    v_cmp_class_f32 vcc, v118, s56
    v_cvt_pk_bf16_f32 v116, v118, v122
    v_cvt_pk_bf16_f32 v117, v126, v130
    v_cvt_pk_bf16_f32 v118, v134, v138
    s_or_b64 s[46:47], s[46:47], vcc
    buffer_store_dwordx3 v[116:118], v4, s[32:35], s61 offen offset:768 sc0 sc1
    v_cmp_class_f32 vcc, v119, s56
    v_cvt_pk_bf16_f32 v120, v119, v123
    v_cvt_pk_bf16_f32 v121, v127, v131
    v_cvt_pk_bf16_f32 v122, v135, v139
    s_or_b64 s[46:47], s[46:47], vcc
    s_mov_b64 exec, s[44:45]
    buffer_store_dwordx3 v[120:122], v4, s[32:35], s61 offen offset:1152 sc0 sc1
    s_mov_b64 exec, -1
    s_waitcnt lgkmcnt(0)
    s_barrier
L_joino:
    ds_read_b128 v[152:155], v3 offset:0
    ds_read_b128 v[140:143], v3 offset:1024
    ds_read_b128 v[144:147], v3 offset:2048
    s_waitcnt lgkmcnt(2)
    v_mfma_f32_16x16x32_bf16 v[116:119], v[152:155], v[44:47], 0
    v_mfma_f32_16x16x32_bf16 v[120:123], v[152:155], v[48:51], 0
    v_mfma_f32_16x16x32_bf16 v[124:127], v[152:155], v[52:55], 0
    v_mfma_f32_16x16x32_bf16 v[128:131], v[152:155], v[56:59], 0
    v_mfma_f32_16x16x32_bf16 v[132:135], v[152:155], v[60:63], 0
    v_mfma_f32_16x16x32_bf16 v[136:139], v[152:155], v[64:67], 0
    s_waitcnt lgkmcnt(1)
    v_mfma_f32_16x16x32_bf16 v[116:119], v[140:143], v[68:71], v[116:119]
    v_mfma_f32_16x16x32_bf16 v[120:123], v[140:143], v[72:75], v[120:123]
    v_mfma_f32_16x16x32_bf16 v[124:127], v[140:143], v[76:79], v[124:127]
    v_mfma_f32_16x16x32_bf16 v[128:131], v[140:143], v[80:83], v[128:131]
    v_mfma_f32_16x16x32_bf16 v[132:135], v[140:143], v[84:87], v[132:135]
    v_mfma_f32_16x16x32_bf16 v[136:139], v[140:143], v[88:91], v[136:139]
    s_waitcnt lgkmcnt(0)
    v_mfma_f32_16x16x32_bf16 v[116:119], v[144:147], v[92:95], v[116:119]
    v_mfma_f32_16x16x32_bf16 v[120:123], v[144:147], v[96:99], v[120:123]
    v_mfma_f32_16x16x32_bf16 v[124:127], v[144:147], v[100:103], v[124:127]
    v_mfma_f32_16x16x32_bf16 v[128:131], v[144:147], v[104:107], v[128:131]
    v_mfma_f32_16x16x32_bf16 v[132:135], v[144:147], v[108:111], v[132:135]
    v_mfma_f32_16x16x32_bf16 v[136:139], v[144:147], v[112:115], v[136:139]
    s_mul_i32 s61, s41, 4
    s_ashr_i32 s61, s61, 1
    s_add_u32 s61, s61, s43
    v_cmp_class_f32 vcc, v116, s56
    v_cvt_pk_bf16_f32 v0, v116, v120
    s_nop 0
    v_cvt_pk_bf16_f32 v1, v124, v128
    s_nop 0
    v_cvt_pk_bf16_f32 v2, v132, v136
    s_or_b64 s[46:47], s[46:47], vcc
    buffer_store_dwordx3 v[0:2], v4, s[32:35], s61 offen offset:0 sc0 sc1
    v_cmp_class_f32 vcc, v117, s56
    s_nop 0
    v_cvt_pk_bf16_f32 v0, v117, v121
    v_cvt_pk_bf16_f32 v1, v125, v129
    v_cvt_pk_bf16_f32 v2, v133, v137
    s_or_b64 s[46:47], s[46:47], vcc
    buffer_store_dwordx3 v[0:2], v4, s[32:35], s61 offen offset:384 sc0 sc1
    v_cmp_class_f32 vcc, v118, s56
    v_cvt_pk_bf16_f32 v116, v118, v122
    v_cvt_pk_bf16_f32 v117, v126, v130
    v_cvt_pk_bf16_f32 v118, v134, v138
    s_or_b64 s[46:47], s[46:47], vcc
    buffer_store_dwordx3 v[116:118], v4, s[32:35], s61 offen offset:768 sc0 sc1
    v_cmp_class_f32 vcc, v119, s56
    v_cvt_pk_bf16_f32 v120, v119, v123
    v_cvt_pk_bf16_f32 v121, v127, v131
    v_cvt_pk_bf16_f32 v122, v135, v139
    s_or_b64 s[46:47], s[46:47], vcc
    s_mov_b64 exec, s[44:45]
    buffer_store_dwordx3 v[120:122], v4, s[32:35], s61 offen offset:1152 sc0 sc1
    s_mov_b64 exec, -1
    s_waitcnt lgkmcnt(0)
    s_barrier
    ds_read_b128 v[148:151], v3 offset:6144
    ds_read_b128 v[152:155], v3 offset:7168
    ds_read_b128 v[140:143], v3 offset:8192
    s_waitcnt lgkmcnt(2)
    v_mfma_f32_16x16x32_bf16 v[116:119], v[148:151], v[44:47], 0
    v_mfma_f32_16x16x32_bf16 v[120:123], v[148:151], v[48:51], 0
    v_mfma_f32_16x16x32_bf16 v[124:127], v[148:151], v[52:55], 0
    v_mfma_f32_16x16x32_bf16 v[128:131], v[148:151], v[56:59], 0
    v_mfma_f32_16x16x32_bf16 v[132:135], v[148:151], v[60:63], 0
    v_mfma_f32_16x16x32_bf16 v[136:139], v[148:151], v[64:67], 0
    s_waitcnt lgkmcnt(1)
    v_mfma_f32_16x16x32_bf16 v[116:119], v[152:155], v[68:71], v[116:119]
    v_mfma_f32_16x16x32_bf16 v[120:123], v[152:155], v[72:75], v[120:123]
    v_mfma_f32_16x16x32_bf16 v[124:127], v[152:155], v[76:79], v[124:127]
    v_mfma_f32_16x16x32_bf16 v[128:131], v[152:155], v[80:83], v[128:131]
    v_mfma_f32_16x16x32_bf16 v[132:135], v[152:155], v[84:87], v[132:135]
    v_mfma_f32_16x16x32_bf16 v[136:139], v[152:155], v[88:91], v[136:139]
    s_waitcnt lgkmcnt(0)
    v_mfma_f32_16x16x32_bf16 v[116:119], v[140:143], v[92:95], v[116:119]
    v_mfma_f32_16x16x32_bf16 v[120:123], v[140:143], v[96:99], v[120:123]
    v_mfma_f32_16x16x32_bf16 v[124:127], v[140:143], v[100:103], v[124:127]
    v_mfma_f32_16x16x32_bf16 v[128:131], v[140:143], v[104:107], v[128:131]
    v_mfma_f32_16x16x32_bf16 v[132:135], v[140:143], v[108:111], v[132:135]
    v_mfma_f32_16x16x32_bf16 v[136:139], v[140:143], v[112:115], v[136:139]
    s_mul_i32 s61, s41, 5
    s_ashr_i32 s61, s61, 1
    s_add_u32 s61, s61, s43
    v_cmp_class_f32 vcc, v116, s56
    v_cvt_pk_bf16_f32 v0, v116, v120
    s_nop 0
    v_cvt_pk_bf16_f32 v1, v124, v128
    s_nop 0
    v_cvt_pk_bf16_f32 v2, v132, v136
    s_or_b64 s[46:47], s[46:47], vcc
    buffer_store_dwordx3 v[0:2], v4, s[32:35], s61 offen offset:0 sc0 sc1
    v_cmp_class_f32 vcc, v117, s56
    s_nop 0
    v_cvt_pk_bf16_f32 v0, v117, v121
    v_cvt_pk_bf16_f32 v1, v125, v129
    v_cvt_pk_bf16_f32 v2, v133, v137
    s_or_b64 s[46:47], s[46:47], vcc
    buffer_store_dwordx3 v[0:2], v4, s[32:35], s61 offen offset:384 sc0 sc1
    v_cmp_class_f32 vcc, v118, s56
    v_cvt_pk_bf16_f32 v116, v118, v122
    v_cvt_pk_bf16_f32 v117, v126, v130
    v_cvt_pk_bf16_f32 v118, v134, v138
    s_or_b64 s[46:47], s[46:47], vcc
    buffer_store_dwordx3 v[116:118], v4, s[32:35], s61 offen offset:768 sc0 sc1
    v_cmp_class_f32 vcc, v119, s56
    v_cvt_pk_bf16_f32 v120, v119, v123
    v_cvt_pk_bf16_f32 v121, v127, v131
    v_cvt_pk_bf16_f32 v122, v135, v139
    s_or_b64 s[46:47], s[46:47], vcc
    s_mov_b64 exec, s[44:45]
    buffer_store_dwordx3 v[120:122], v4, s[32:35], s61 offen offset:1152 sc0 sc1
    s_mov_b64 exec, -1
    s_waitcnt lgkmcnt(0)
    s_barrier
    ds_read_b128 v[144:147], v3 offset:12288
    ds_read_b128 v[148:151], v3 offset:13312
    ds_read_b128 v[152:155], v3 offset:14336
    s_waitcnt lgkmcnt(2)
    v_mfma_f32_16x16x32_bf16 v[116:119], v[144:147], v[44:47], 0
    v_mfma_f32_16x16x32_bf16 v[120:123], v[144:147], v[48:51], 0
    v_mfma_f32_16x16x32_bf16 v[124:127], v[144:147], v[52:55], 0
    v_mfma_f32_16x16x32_bf16 v[128:131], v[144:147], v[56:59], 0
    v_mfma_f32_16x16x32_bf16 v[132:135], v[144:147], v[60:63], 0
    v_mfma_f32_16x16x32_bf16 v[136:139], v[144:147], v[64:67], 0
    s_waitcnt lgkmcnt(1)
    v_mfma_f32_16x16x32_bf16 v[116:119], v[148:151], v[68:71], v[116:119]
    v_mfma_f32_16x16x32_bf16 v[120:123], v[148:151], v[72:75], v[120:123]
    v_mfma_f32_16x16x32_bf16 v[124:127], v[148:151], v[76:79], v[124:127]
    v_mfma_f32_16x16x32_bf16 v[128:131], v[148:151], v[80:83], v[128:131]
    v_mfma_f32_16x16x32_bf16 v[132:135], v[148:151], v[84:87], v[132:135]
    v_mfma_f32_16x16x32_bf16 v[136:139], v[148:151], v[88:91], v[136:139]
    s_waitcnt lgkmcnt(0)
    v_mfma_f32_16x16x32_bf16 v[116:119], v[152:155], v[92:95], v[116:119]
    v_mfma_f32_16x16x32_bf16 v[120:123], v[152:155], v[96:99], v[120:123]
    v_mfma_f32_16x16x32_bf16 v[124:127], v[152:155], v[100:103], v[124:127]
    v_mfma_f32_16x16x32_bf16 v[128:131], v[152:155], v[104:107], v[128:131]
    v_mfma_f32_16x16x32_bf16 v[132:135], v[152:155], v[108:111], v[132:135]
    v_mfma_f32_16x16x32_bf16 v[136:139], v[152:155], v[112:115], v[136:139]
    s_mul_i32 s61, s41, 6
    s_ashr_i32 s61, s61, 1
    s_add_u32 s61, s61, s43
    v_cmp_class_f32 vcc, v116, s56
    v_cvt_pk_bf16_f32 v0, v116, v120
    s_nop 0
    v_cvt_pk_bf16_f32 v1, v124, v128
    s_nop 0
    v_cvt_pk_bf16_f32 v2, v132, v136
    s_or_b64 s[46:47], s[46:47], vcc
    buffer_store_dwordx3 v[0:2], v4, s[32:35], s61 offen offset:0 sc0 sc1
    v_cmp_class_f32 vcc, v117, s56
    s_nop 0
    v_cvt_pk_bf16_f32 v0, v117, v121
    v_cvt_pk_bf16_f32 v1, v125, v129
    v_cvt_pk_bf16_f32 v2, v133, v137
    s_or_b64 s[46:47], s[46:47], vcc
    buffer_store_dwordx3 v[0:2], v4, s[32:35], s61 offen offset:384 sc0 sc1
    v_cmp_class_f32 vcc, v118, s56
    v_cvt_pk_bf16_f32 v116, v118, v122
    v_cvt_pk_bf16_f32 v117, v126, v130
    v_cvt_pk_bf16_f32 v118, v134, v138
    s_or_b64 s[46:47], s[46:47], vcc
    buffer_store_dwordx3 v[116:118], v4, s[32:35], s61 offen offset:768 sc0 sc1
    v_cmp_class_f32 vcc, v119, s56
    v_cvt_pk_bf16_f32 v120, v119, v123
    v_cvt_pk_bf16_f32 v121, v127, v131
    v_cvt_pk_bf16_f32 v122, v135, v139
    s_or_b64 s[46:47], s[46:47], vcc
    s_mov_b64 exec, s[44:45]
    buffer_store_dwordx3 v[120:122], v4, s[32:35], s61 offen offset:1152 sc0 sc1
    s_mov_b64 exec, -1
    v_mov_b32 v0, 0
    v_mov_b32 v1, 1
    s_mov_b64 exec, s[46:47]
    ds_write_b32 v0, v1
    s_mov_b64 exec, -1
L_fin:
    s_waitcnt lgkmcnt(0)
    s_barrier
    v_mov_b32 v1, 0
    ds_read_b32 v1, v1
    s_waitcnt lgkmcnt(0)
    v_readfirstlane_b32 s61, v1
    s_cmp_lg_u32 s36, 0
    s_cselect_b32 s61, 0, s61
    s_cmp_eq_u32 s61, 0
    s_cbranch_scc1 L_done
    s_mov_b32 s36, 1
    v_mbcnt_lo_u32_b32 v0, -1, 0
    v_mbcnt_hi_u32_b32 v0, -1, v0
    s_waitcnt vmcnt(0)
    s_barrier
    s_branch L_restart
L_done:
L_end:
    s_endpgm
L_edgeq:
    v_mul_f32 v116, s56, v116
    v_mul_f32 v117, s56, v117
    v_mul_f32 v118, s56, v118
    v_mul_f32 v119, s56, v119
    v_mul_f32 v120, s56, v120
    v_mul_f32 v121, s56, v121
    v_mul_f32 v122, s56, v122
    v_mul_f32 v123, s56, v123
    v_cvt_pk_bf16_f32 v116, v116, v117
    v_cvt_pk_bf16_f32 v117, v118, v119
    v_cvt_pk_bf16_f32 v118, v120, v121
    v_cvt_pk_bf16_f32 v119, v122, v123
    ds_write_b128 v4, v[116:119] offset:6144
    v_mul_f32 v124, s56, v124
    v_mul_f32 v125, s56, v125
    v_mul_f32 v126, s56, v126
    v_mul_f32 v127, s56, v127
    v_mul_f32 v128, s56, v128
    v_mul_f32 v129, s56, v129
    v_mul_f32 v130, s56, v130
    v_mul_f32 v131, s56, v131
    v_cvt_pk_bf16_f32 v124, v124, v125
    v_cvt_pk_bf16_f32 v125, v126, v127
    v_cvt_pk_bf16_f32 v126, v128, v129
    v_cvt_pk_bf16_f32 v127, v130, v131
    ds_write_b128 v4, v[124:127] offset:6400
    v_mul_f32 v132, s56, v132
    v_mul_f32 v133, s56, v133
    v_mul_f32 v134, s56, v134
    v_mul_f32 v135, s56, v135
    v_mul_f32 v136, s56, v136
    v_mul_f32 v137, s56, v137
    v_mul_f32 v138, s56, v138
    v_mul_f32 v139, s56, v139
    v_cvt_pk_bf16_f32 v132, v132, v133
    v_cvt_pk_bf16_f32 v133, v134, v135
    v_cvt_pk_bf16_f32 v134, v136, v137
    v_cvt_pk_bf16_f32 v135, v138, v139
    ds_write_b128 v4, v[132:135] offset:6656
    s_waitcnt lgkmcnt(0)
    s_barrier
    s_branch L_joinq
L_edgeo:
    ds_read_b128 v[140:143], v3 offset:12288
    ds_read_b128 v[144:147], v3 offset:13312
    ds_read_b128 v[148:151], v3 offset:14336
    s_waitcnt lgkmcnt(2)
    v_mfma_f32_16x16x32_bf16 v[116:119], v[140:143], v[44:47], 0
    v_mfma_f32_16x16x32_bf16 v[120:123], v[140:143], v[48:51], 0
    v_mfma_f32_16x16x32_bf16 v[124:127], v[140:143], v[52:55], 0
    v_mfma_f32_16x16x32_bf16 v[128:131], v[140:143], v[56:59], 0
    v_mfma_f32_16x16x32_bf16 v[132:135], v[140:143], v[60:63], 0
    v_mfma_f32_16x16x32_bf16 v[136:139], v[140:143], v[64:67], 0
    s_waitcnt lgkmcnt(1)
    v_mfma_f32_16x16x32_bf16 v[116:119], v[144:147], v[68:71], v[116:119]
    v_mfma_f32_16x16x32_bf16 v[120:123], v[144:147], v[72:75], v[120:123]
    v_mfma_f32_16x16x32_bf16 v[124:127], v[144:147], v[76:79], v[124:127]
    v_mfma_f32_16x16x32_bf16 v[128:131], v[144:147], v[80:83], v[128:131]
    v_mfma_f32_16x16x32_bf16 v[132:135], v[144:147], v[84:87], v[132:135]
    v_mfma_f32_16x16x32_bf16 v[136:139], v[144:147], v[88:91], v[136:139]
    s_waitcnt lgkmcnt(0)
    v_mfma_f32_16x16x32_bf16 v[116:119], v[148:151], v[92:95], v[116:119]
    v_mfma_f32_16x16x32_bf16 v[120:123], v[148:151], v[96:99], v[120:123]
    v_mfma_f32_16x16x32_bf16 v[124:127], v[148:151], v[100:103], v[124:127]
    v_mfma_f32_16x16x32_bf16 v[128:131], v[148:151], v[104:107], v[128:131]
    v_mfma_f32_16x16x32_bf16 v[132:135], v[148:151], v[108:111], v[132:135]
    v_mfma_f32_16x16x32_bf16 v[136:139], v[148:151], v[112:115], v[136:139]
    s_mul_i32 s61, s41, 3
    s_ashr_i32 s61, s61, 1
    s_add_u32 s61, s61, s43
    v_cmp_class_f32 vcc, v116, s56
    v_cvt_pk_bf16_f32 v0, v116, v120
    s_nop 0
    v_cvt_pk_bf16_f32 v1, v124, v128
    s_nop 0
    v_cvt_pk_bf16_f32 v2, v132, v136
    s_or_b64 s[46:47], s[46:47], vcc
    buffer_store_dwordx3 v[0:2], v4, s[32:35], s61 offen offset:0 sc0 sc1
    v_cmp_class_f32 vcc, v117, s56
    s_nop 0
    v_cvt_pk_bf16_f32 v0, v117, v121
    v_cvt_pk_bf16_f32 v1, v125, v129
    v_cvt_pk_bf16_f32 v2, v133, v137
    s_or_b64 s[46:47], s[46:47], vcc
    buffer_store_dwordx3 v[0:2], v4, s[32:35], s61 offen offset:384 sc0 sc1
    v_cmp_class_f32 vcc, v118, s56
    v_cvt_pk_bf16_f32 v116, v118, v122
    v_cvt_pk_bf16_f32 v117, v126, v130
    v_cvt_pk_bf16_f32 v118, v134, v138
    s_or_b64 s[46:47], s[46:47], vcc
    buffer_store_dwordx3 v[116:118], v4, s[32:35], s61 offen offset:768 sc0 sc1
    v_cmp_class_f32 vcc, v119, s56
    v_cvt_pk_bf16_f32 v120, v119, v123
    v_cvt_pk_bf16_f32 v121, v127, v131
    v_cvt_pk_bf16_f32 v122, v135, v139
    s_or_b64 s[46:47], s[46:47], vcc
    s_mov_b64 exec, s[44:45]
    buffer_store_dwordx3 v[120:122], v4, s[32:35], s61 offen offset:1152 sc0 sc1
    s_mov_b64 exec, -1
    s_waitcnt lgkmcnt(0)
    s_barrier
    s_branch L_joino
L_slow:
    s_mov_b64 exec, s[44:45]
    ds_read_b128 v[144:147], v154 offset:6144
    s_mov_b64 exec, -1
    v_xor_b32 v163, 16, v0
    v_lshlrev_b32 v163, 2, v163
    ds_read_b128 v[8:11], v148 offset:0
    ds_read_b128 v[12:15], v149 offset:2800
    ds_read_b64_tr_b16 v[40:41], v150 offset:64
    ds_read_b64_tr_b16 v[42:43], v152 offset:2864
    ds_read_b64_tr_b16 v[44:45], v151 offset:80
    ds_read_b64_tr_b16 v[46:47], v153 offset:2880
    ds_read_b128 v[16:19], v148 offset:16000
    ds_read_b128 v[20:23], v149 offset:18800
    ds_read_b64_tr_b16 v[48:49], v150 offset:16064
    ds_read_b64_tr_b16 v[50:51], v152 offset:18864
    ds_read_b64_tr_b16 v[52:53], v151 offset:16080
    ds_read_b64_tr_b16 v[54:55], v153 offset:18880
    s_waitcnt lgkmcnt(0)
    v_mfma_f32_16x16x32_bf16 v[120:123], v[24:27], v[144:147], v[72:75]
    v_mfma_f32_16x16x32_bf16 v[124:127], v[28:31], v[144:147], v[72:75]
    v_mfma_f32_16x16x32_bf16 v[128:131], v[32:35], v[144:147], v[76:79]
    v_mfma_f32_16x16x32_bf16 v[132:135], v[36:39], v[144:147], v[76:79]
    v_mfma_f32_16x16x32_bf16 v[104:107], v[8:11], v[144:147], v[80:83]
    v_mfma_f32_16x16x32_bf16 v[108:111], v[12:15], v[144:147], v[80:83]
    v_mfma_f32_16x16x32_bf16 v[112:115], v[16:19], v[144:147], v[84:87]
    v_mfma_f32_16x16x32_bf16 v[116:119], v[20:23], v[144:147], v[84:87]
    s_mov_b64 exec, s[44:45]
    ds_read_b128 v[164:167], v154 offset:12288
    s_mov_b64 exec, -1
    v_cndmask_b32 v120, v124, v120, s[46:47]
    v_cndmask_b32 v121, v125, v121, s[46:47]
    v_cndmask_b32 v122, v126, v122, s[48:49]
    v_cndmask_b32 v123, v127, v123, s[48:49]
    v_cndmask_b32 v128, v132, v128, s[46:47]
    v_cndmask_b32 v129, v133, v129, s[46:47]
    v_cndmask_b32 v130, v134, v130, s[48:49]
    v_cndmask_b32 v131, v135, v131, s[48:49]
    v_cndmask_b32 v104, v108, v104, s[46:47]
    v_cndmask_b32 v105, v109, v105, s[46:47]
    v_cndmask_b32 v106, v110, v106, s[48:49]
    v_cndmask_b32 v107, v111, v107, s[48:49]
    v_cndmask_b32 v112, v116, v112, s[46:47]
    v_cndmask_b32 v113, v117, v113, s[46:47]
    v_cndmask_b32 v114, v118, v114, s[48:49]
    v_cndmask_b32 v115, v119, v115, s[48:49]
    v_max_f32 v161, v104, v105
    v_max3_f32 v161, v161, v106, v107
    v_max3_f32 v161, v161, v112, v113
    v_max3_f32 v161, v161, v114, v115
    v_max3_f32 v161, v161, v120, v121
    v_max3_f32 v161, v161, v122, v123
    v_max3_f32 v161, v161, v128, v129
    v_max3_f32 v161, v161, v130, v131
    ds_bpermute_b32 v162, v163, v161
    v_xor_b32 v163, 192, v163
    s_waitcnt lgkmcnt(0)
    v_max_f32 v161, v161, v162
    ds_bpermute_b32 v162, v163, v161
    v_xor_b32 v163, 192, v163
    s_waitcnt lgkmcnt(0)
    v_max_f32 v161, v161, v162
    v_sub_f32 v104, v104, v161
    v_sub_f32 v105, v105, v161
    v_sub_f32 v106, v106, v161
    v_sub_f32 v107, v107, v161
    v_sub_f32 v112, v112, v161
    v_sub_f32 v113, v113, v161
    v_sub_f32 v114, v114, v161
    v_sub_f32 v115, v115, v161
    v_sub_f32 v120, v120, v161
    v_sub_f32 v121, v121, v161
    v_sub_f32 v122, v122, v161
    v_sub_f32 v123, v123, v161
    v_sub_f32 v128, v128, v161
    v_sub_f32 v129, v129, v161
    v_sub_f32 v130, v130, v161
    v_sub_f32 v131, v131, v161
    v_exp_f32 v120, v120
    v_exp_f32 v121, v121
    v_exp_f32 v122, v122
    v_exp_f32 v123, v123
    s_mov_b64 exec, s[46:47]
    v_cvt_pk_bf16_f32 v96, v120, v121
    s_mov_b64 exec, s[50:51]
    v_cvt_pk_bf16_f32 v98, v120, v121
    s_mov_b64 exec, -1
    s_mov_b64 exec, s[48:49]
    v_cvt_pk_bf16_f32 v97, v122, v123
    s_mov_b64 exec, s[8:9]
    v_cvt_pk_bf16_f32 v99, v122, v123
    s_mov_b64 exec, -1
    s_nop 0
    v_mfma_f32_16x16x32_bf16 v[136:139], v[56:59], v[96:99], 0
    v_mfma_f32_16x16x32_bf16 v[140:143], v[60:63], v[96:99], 0
    v_exp_f32 v128, v128
    v_exp_f32 v129, v129
    v_exp_f32 v130, v130
    v_exp_f32 v131, v131
    s_mov_b64 exec, s[46:47]
    v_cvt_pk_bf16_f32 v100, v128, v129
    s_mov_b64 exec, s[50:51]
    v_cvt_pk_bf16_f32 v102, v128, v129
    s_mov_b64 exec, -1
    s_mov_b64 exec, s[48:49]
    v_cvt_pk_bf16_f32 v101, v130, v131
    s_mov_b64 exec, s[8:9]
    v_cvt_pk_bf16_f32 v103, v130, v131
    s_mov_b64 exec, -1
    s_nop 0
    v_mfma_f32_16x16x32_bf16 v[136:139], v[64:67], v[100:103], v[136:139]
    v_mfma_f32_16x16x32_bf16 v[140:143], v[68:71], v[100:103], v[140:143]
    v_exp_f32 v104, v104
    v_exp_f32 v105, v105
    v_exp_f32 v106, v106
    v_exp_f32 v107, v107
    s_mov_b64 exec, s[46:47]
    v_cvt_pk_bf16_f32 v88, v104, v105
    s_mov_b64 exec, s[50:51]
    v_cvt_pk_bf16_f32 v90, v104, v105
    s_mov_b64 exec, -1
    s_mov_b64 exec, s[48:49]
    v_cvt_pk_bf16_f32 v89, v106, v107
    s_mov_b64 exec, s[8:9]
    v_cvt_pk_bf16_f32 v91, v106, v107
    s_mov_b64 exec, -1
    s_nop 0
    v_mfma_f32_16x16x32_bf16 v[136:139], v[40:43], v[88:91], v[136:139]
    v_mfma_f32_16x16x32_bf16 v[140:143], v[44:47], v[88:91], v[140:143]
    v_exp_f32 v112, v112
    v_exp_f32 v113, v113
    v_exp_f32 v114, v114
    v_exp_f32 v115, v115
    s_mov_b64 exec, s[46:47]
    v_cvt_pk_bf16_f32 v92, v112, v113
    s_mov_b64 exec, s[50:51]
    v_cvt_pk_bf16_f32 v94, v112, v113
    s_mov_b64 exec, -1
    s_mov_b64 exec, s[48:49]
    v_cvt_pk_bf16_f32 v93, v114, v115
    s_mov_b64 exec, s[8:9]
    v_cvt_pk_bf16_f32 v95, v114, v115
    s_mov_b64 exec, -1
    s_nop 0
    v_mfma_f32_16x16x32_bf16 v[136:139], v[48:51], v[92:95], v[136:139]
    v_mfma_f32_16x16x32_bf16 v[140:143], v[52:55], v[92:95], v[140:143]
    s_nop 7
    v_permlane32_swap_b32 v140, v142
    v_permlane32_swap_b32 v141, v143
    v_rcp_f32 v160, v142
    s_nop 0
    v_max3_f32 v159, v159, v142, v160
    v_mul_f32 v136, v136, v160
    v_mul_f32 v137, v137, v160
    v_mul_f32 v138, v138, v160
    v_mul_f32 v139, v139, v160
    v_cvt_pk_bf16_f32 v136, v136, v137
    v_cvt_pk_bf16_f32 v137, v138, v139
    v_mul_f32 v140, v140, v160
    v_mul_f32 v141, v141, v160
    ds_write_b64 v155, v[136:137] offset:12288
    v_cvt_pk_bf16_f32 v140, v140, v141
    ds_write_b32 v156, v140 offset:12800
    s_waitcnt vmcnt(0) lgkmcnt(0)
    s_barrier
    s_mul_i32 s61, s41, 4
    s_add_u32 s61, s61, s40
    v_add_u32 v157, s61, v157
    s_add_u32 s61, s61, 1920
    v_add_u32 v158, s61, v158
    s_mov_b32 exec_hi, 0x0fffffff
    s_add_u32 m0, s54, 61440
    s_nop 0
    buffer_load_dwordx4 v157, s[16:19], 0 offen nt lds
    s_add_u32 m0, s54, 62400
    s_nop 0
    buffer_load_dwordx4 v158, s[16:19], 0 offen nt lds
    s_mov_b32 exec_hi, -1
    ds_read_b128 v[24:27], v148 offset:32000
    ds_read_b128 v[28:31], v149 offset:34800
    ds_read_b64_tr_b16 v[56:57], v150 offset:32064
    ds_read_b64_tr_b16 v[58:59], v152 offset:34864
    ds_read_b64_tr_b16 v[60:61], v151 offset:32080
    ds_read_b64_tr_b16 v[62:63], v153 offset:34880
    s_waitcnt lgkmcnt(0)
    v_mfma_f32_16x16x32_bf16 v[128:131], v[32:35], v[164:167], v[72:75]
    v_mfma_f32_16x16x32_bf16 v[132:135], v[36:39], v[164:167], v[72:75]
    v_mfma_f32_16x16x32_bf16 v[104:107], v[8:11], v[164:167], v[76:79]
    v_mfma_f32_16x16x32_bf16 v[108:111], v[12:15], v[164:167], v[76:79]
    v_mfma_f32_16x16x32_bf16 v[112:115], v[16:19], v[164:167], v[80:83]
    v_mfma_f32_16x16x32_bf16 v[116:119], v[20:23], v[164:167], v[80:83]
    v_mfma_f32_16x16x32_bf16 v[120:123], v[24:27], v[164:167], v[84:87]
    v_mfma_f32_16x16x32_bf16 v[124:127], v[28:31], v[164:167], v[84:87]
    s_mov_b64 exec, s[44:45]
    ds_read_b128 v[144:147], v154 offset:0
    s_mov_b64 exec, -1
    v_cndmask_b32 v128, v132, v128, s[46:47]
    v_cndmask_b32 v129, v133, v129, s[46:47]
    v_cndmask_b32 v130, v134, v130, s[48:49]
    v_cndmask_b32 v131, v135, v131, s[48:49]
    v_cndmask_b32 v104, v108, v104, s[46:47]
    v_cndmask_b32 v105, v109, v105, s[46:47]
    v_cndmask_b32 v106, v110, v106, s[48:49]
    v_cndmask_b32 v107, v111, v107, s[48:49]
    v_cndmask_b32 v112, v116, v112, s[46:47]
    v_cndmask_b32 v113, v117, v113, s[46:47]
    v_cndmask_b32 v114, v118, v114, s[48:49]
    v_cndmask_b32 v115, v119, v115, s[48:49]
    v_cndmask_b32 v120, v124, v120, s[46:47]
    v_cndmask_b32 v121, v125, v121, s[46:47]
    v_cndmask_b32 v122, v126, v122, s[48:49]
    v_cndmask_b32 v123, v127, v123, s[48:49]
    v_max_f32 v161, v104, v105
    v_max3_f32 v161, v161, v106, v107
    v_max3_f32 v161, v161, v112, v113
    v_max3_f32 v161, v161, v114, v115
    v_max3_f32 v161, v161, v120, v121
    v_max3_f32 v161, v161, v122, v123
    v_max3_f32 v161, v161, v128, v129
    v_max3_f32 v161, v161, v130, v131
    ds_bpermute_b32 v162, v163, v161
    v_xor_b32 v163, 192, v163
    s_waitcnt lgkmcnt(0)
    v_max_f32 v161, v161, v162
    ds_bpermute_b32 v162, v163, v161
    v_xor_b32 v163, 192, v163
    s_waitcnt lgkmcnt(0)
    v_max_f32 v161, v161, v162
    v_sub_f32 v104, v104, v161
    v_sub_f32 v105, v105, v161
    v_sub_f32 v106, v106, v161
    v_sub_f32 v107, v107, v161
    v_sub_f32 v112, v112, v161
    v_sub_f32 v113, v113, v161
    v_sub_f32 v114, v114, v161
    v_sub_f32 v115, v115, v161
    v_sub_f32 v120, v120, v161
    v_sub_f32 v121, v121, v161
    v_sub_f32 v122, v122, v161
    v_sub_f32 v123, v123, v161
    v_sub_f32 v128, v128, v161
    v_sub_f32 v129, v129, v161
    v_sub_f32 v130, v130, v161
    v_sub_f32 v131, v131, v161
    v_exp_f32 v128, v128
    v_exp_f32 v129, v129
    v_exp_f32 v130, v130
    v_exp_f32 v131, v131
    s_mov_b64 exec, s[46:47]
    v_cvt_pk_bf16_f32 v100, v128, v129
    s_mov_b64 exec, s[50:51]
    v_cvt_pk_bf16_f32 v102, v128, v129
    s_mov_b64 exec, -1
    s_mov_b64 exec, s[48:49]
    v_cvt_pk_bf16_f32 v101, v130, v131
    s_mov_b64 exec, s[8:9]
    v_cvt_pk_bf16_f32 v103, v130, v131
    s_mov_b64 exec, -1
    s_nop 0
    v_mfma_f32_16x16x32_bf16 v[136:139], v[64:67], v[100:103], 0
    v_mfma_f32_16x16x32_bf16 v[140:143], v[68:71], v[100:103], 0
    v_exp_f32 v104, v104
    v_exp_f32 v105, v105
    v_exp_f32 v106, v106
    v_exp_f32 v107, v107
    s_mov_b64 exec, s[46:47]
    v_cvt_pk_bf16_f32 v88, v104, v105
    s_mov_b64 exec, s[50:51]
    v_cvt_pk_bf16_f32 v90, v104, v105
    s_mov_b64 exec, -1
    s_mov_b64 exec, s[48:49]
    v_cvt_pk_bf16_f32 v89, v106, v107
    s_mov_b64 exec, s[8:9]
    v_cvt_pk_bf16_f32 v91, v106, v107
    s_mov_b64 exec, -1
    s_nop 0
    v_mfma_f32_16x16x32_bf16 v[136:139], v[40:43], v[88:91], v[136:139]
    v_mfma_f32_16x16x32_bf16 v[140:143], v[44:47], v[88:91], v[140:143]
    v_exp_f32 v112, v112
    v_exp_f32 v113, v113
    v_exp_f32 v114, v114
    v_exp_f32 v115, v115
    s_mov_b64 exec, s[46:47]
    v_cvt_pk_bf16_f32 v92, v112, v113
    s_mov_b64 exec, s[50:51]
    v_cvt_pk_bf16_f32 v94, v112, v113
    s_mov_b64 exec, -1
    s_mov_b64 exec, s[48:49]
    v_cvt_pk_bf16_f32 v93, v114, v115
    s_mov_b64 exec, s[8:9]
    v_cvt_pk_bf16_f32 v95, v114, v115
    s_mov_b64 exec, -1
    s_nop 0
    v_mfma_f32_16x16x32_bf16 v[136:139], v[48:51], v[92:95], v[136:139]
    v_mfma_f32_16x16x32_bf16 v[140:143], v[52:55], v[92:95], v[140:143]
    v_exp_f32 v120, v120
    v_exp_f32 v121, v121
    v_exp_f32 v122, v122
    v_exp_f32 v123, v123
    s_mov_b64 exec, s[46:47]
    v_cvt_pk_bf16_f32 v96, v120, v121
    s_mov_b64 exec, s[50:51]
    v_cvt_pk_bf16_f32 v98, v120, v121
    s_mov_b64 exec, -1
    s_mov_b64 exec, s[48:49]
    v_cvt_pk_bf16_f32 v97, v122, v123
    s_mov_b64 exec, s[8:9]
    v_cvt_pk_bf16_f32 v99, v122, v123
    s_mov_b64 exec, -1
    s_nop 0
    v_mfma_f32_16x16x32_bf16 v[136:139], v[56:59], v[96:99], v[136:139]
    v_mfma_f32_16x16x32_bf16 v[140:143], v[60:63], v[96:99], v[140:143]
    s_nop 7
    v_permlane32_swap_b32 v140, v142
    v_permlane32_swap_b32 v141, v143
    v_rcp_f32 v160, v142
    s_nop 0
    v_max3_f32 v159, v159, v142, v160
    v_mul_f32 v136, v136, v160
    v_mul_f32 v137, v137, v160
    v_mul_f32 v138, v138, v160
    v_mul_f32 v139, v139, v160
    v_cvt_pk_bf16_f32 v136, v136, v137
    v_cvt_pk_bf16_f32 v137, v138, v139
    v_mul_f32 v140, v140, v160
    v_mul_f32 v141, v141, v160
    ds_write_b64 v155, v[136:137] offset:0
    v_cvt_pk_bf16_f32 v140, v140, v141
    ds_write_b32 v156, v140 offset:512
    s_waitcnt lgkmcnt(0)
    s_barrier
    ds_read_b128 v[32:35], v148 offset:48000
    ds_read_b128 v[36:39], v149 offset:50800
    ds_read_b64_tr_b16 v[64:65], v150 offset:48064
    ds_read_b64_tr_b16 v[66:67], v152 offset:50864
    ds_read_b64_tr_b16 v[68:69], v151 offset:48080
    ds_read_b64_tr_b16 v[70:71], v153 offset:50880
    s_waitcnt lgkmcnt(0)
    v_mfma_f32_16x16x32_bf16 v[104:107], v[8:11], v[144:147], v[72:75]
    v_mfma_f32_16x16x32_bf16 v[108:111], v[12:15], v[144:147], v[72:75]
    v_mfma_f32_16x16x32_bf16 v[112:115], v[16:19], v[144:147], v[76:79]
    v_mfma_f32_16x16x32_bf16 v[116:119], v[20:23], v[144:147], v[76:79]
    v_mfma_f32_16x16x32_bf16 v[120:123], v[24:27], v[144:147], v[80:83]
    v_mfma_f32_16x16x32_bf16 v[124:127], v[28:31], v[144:147], v[80:83]
    v_mfma_f32_16x16x32_bf16 v[128:131], v[32:35], v[144:147], v[84:87]
    v_mfma_f32_16x16x32_bf16 v[132:135], v[36:39], v[144:147], v[84:87]
    s_mov_b64 exec, s[44:45]
    ds_read_b128 v[164:167], v154 offset:6144
    s_mov_b64 exec, -1
    v_cndmask_b32 v104, v108, v104, s[46:47]
    v_cndmask_b32 v105, v109, v105, s[46:47]
    v_cndmask_b32 v106, v110, v106, s[48:49]
    v_cndmask_b32 v107, v111, v107, s[48:49]
    v_cndmask_b32 v112, v116, v112, s[46:47]
    v_cndmask_b32 v113, v117, v113, s[46:47]
    v_cndmask_b32 v114, v118, v114, s[48:49]
    v_cndmask_b32 v115, v119, v115, s[48:49]
    v_cndmask_b32 v120, v124, v120, s[46:47]
    v_cndmask_b32 v121, v125, v121, s[46:47]
    v_cndmask_b32 v122, v126, v122, s[48:49]
    v_cndmask_b32 v123, v127, v123, s[48:49]
    v_cndmask_b32 v128, v132, v128, s[46:47]
    v_cndmask_b32 v129, v133, v129, s[46:47]
    v_cndmask_b32 v130, v134, v130, s[48:49]
    v_cndmask_b32 v131, v135, v131, s[48:49]
    v_max_f32 v161, v104, v105
    v_max3_f32 v161, v161, v106, v107
    v_max3_f32 v161, v161, v112, v113
    v_max3_f32 v161, v161, v114, v115
    v_max3_f32 v161, v161, v120, v121
    v_max3_f32 v161, v161, v122, v123
    v_max3_f32 v161, v161, v128, v129
    v_max3_f32 v161, v161, v130, v131
    ds_bpermute_b32 v162, v163, v161
    v_xor_b32 v163, 192, v163
    s_waitcnt lgkmcnt(0)
    v_max_f32 v161, v161, v162
    ds_bpermute_b32 v162, v163, v161
    v_xor_b32 v163, 192, v163
    s_waitcnt lgkmcnt(0)
    v_max_f32 v161, v161, v162
    v_sub_f32 v104, v104, v161
    v_sub_f32 v105, v105, v161
    v_sub_f32 v106, v106, v161
    v_sub_f32 v107, v107, v161
    v_sub_f32 v112, v112, v161
    v_sub_f32 v113, v113, v161
    v_sub_f32 v114, v114, v161
    v_sub_f32 v115, v115, v161
    v_sub_f32 v120, v120, v161
    v_sub_f32 v121, v121, v161
    v_sub_f32 v122, v122, v161
    v_sub_f32 v123, v123, v161
    v_sub_f32 v128, v128, v161
    v_sub_f32 v129, v129, v161
    v_sub_f32 v130, v130, v161
    v_sub_f32 v131, v131, v161
    v_exp_f32 v104, v104
    v_exp_f32 v105, v105
    v_exp_f32 v106, v106
    v_exp_f32 v107, v107
    s_mov_b64 exec, s[46:47]
    v_cvt_pk_bf16_f32 v88, v104, v105
    s_mov_b64 exec, s[50:51]
    v_cvt_pk_bf16_f32 v90, v104, v105
    s_mov_b64 exec, -1
    s_mov_b64 exec, s[48:49]
    v_cvt_pk_bf16_f32 v89, v106, v107
    s_mov_b64 exec, s[8:9]
    v_cvt_pk_bf16_f32 v91, v106, v107
    s_mov_b64 exec, -1
    s_nop 0
    v_mfma_f32_16x16x32_bf16 v[136:139], v[40:43], v[88:91], 0
    v_mfma_f32_16x16x32_bf16 v[140:143], v[44:47], v[88:91], 0
    v_exp_f32 v112, v112
    v_exp_f32 v113, v113
    v_exp_f32 v114, v114
    v_exp_f32 v115, v115
    s_mov_b64 exec, s[46:47]
    v_cvt_pk_bf16_f32 v92, v112, v113
    s_mov_b64 exec, s[50:51]
    v_cvt_pk_bf16_f32 v94, v112, v113
    s_mov_b64 exec, -1
    s_mov_b64 exec, s[48:49]
    v_cvt_pk_bf16_f32 v93, v114, v115
    s_mov_b64 exec, s[8:9]
    v_cvt_pk_bf16_f32 v95, v114, v115
    s_mov_b64 exec, -1
    s_nop 0
    v_mfma_f32_16x16x32_bf16 v[136:139], v[48:51], v[92:95], v[136:139]
    v_mfma_f32_16x16x32_bf16 v[140:143], v[52:55], v[92:95], v[140:143]
    v_exp_f32 v120, v120
    v_exp_f32 v121, v121
    v_exp_f32 v122, v122
    v_exp_f32 v123, v123
    s_mov_b64 exec, s[46:47]
    v_cvt_pk_bf16_f32 v96, v120, v121
    s_mov_b64 exec, s[50:51]
    v_cvt_pk_bf16_f32 v98, v120, v121
    s_mov_b64 exec, -1
    s_mov_b64 exec, s[48:49]
    v_cvt_pk_bf16_f32 v97, v122, v123
    s_mov_b64 exec, s[8:9]
    v_cvt_pk_bf16_f32 v99, v122, v123
    s_mov_b64 exec, -1
    s_nop 0
    v_mfma_f32_16x16x32_bf16 v[136:139], v[56:59], v[96:99], v[136:139]
    v_mfma_f32_16x16x32_bf16 v[140:143], v[60:63], v[96:99], v[140:143]
    v_exp_f32 v128, v128
    v_exp_f32 v129, v129
    v_exp_f32 v130, v130
    v_exp_f32 v131, v131
    s_mov_b64 exec, s[46:47]
    v_cvt_pk_bf16_f32 v100, v128, v129
    s_mov_b64 exec, s[50:51]
    v_cvt_pk_bf16_f32 v102, v128, v129
    s_mov_b64 exec, -1
    s_mov_b64 exec, s[48:49]
    v_cvt_pk_bf16_f32 v101, v130, v131
    s_mov_b64 exec, s[8:9]
    v_cvt_pk_bf16_f32 v103, v130, v131
    s_mov_b64 exec, -1
    s_nop 0
    v_mfma_f32_16x16x32_bf16 v[136:139], v[64:67], v[100:103], v[136:139]
    v_mfma_f32_16x16x32_bf16 v[140:143], v[68:71], v[100:103], v[140:143]
    s_nop 7
    v_permlane32_swap_b32 v140, v142
    v_permlane32_swap_b32 v141, v143
    v_rcp_f32 v160, v142
    s_nop 0
    v_max3_f32 v159, v159, v142, v160
    v_mul_f32 v136, v136, v160
    v_mul_f32 v137, v137, v160
    v_mul_f32 v138, v138, v160
    v_mul_f32 v139, v139, v160
    v_cvt_pk_bf16_f32 v136, v136, v137
    v_cvt_pk_bf16_f32 v137, v138, v139
    v_mul_f32 v140, v140, v160
    v_mul_f32 v141, v141, v160
    ds_write_b64 v155, v[136:137] offset:6144
    v_cvt_pk_bf16_f32 v140, v140, v141
    ds_write_b32 v156, v140 offset:6656
    s_waitcnt vmcnt(0) lgkmcnt(0)
    s_barrier
    ds_read_b128 v[8:11], v148 offset:0
    ds_read_b128 v[12:15], v149 offset:2800
    ds_read_b64_tr_b16 v[40:41], v150 offset:64
    ds_read_b64_tr_b16 v[42:43], v152 offset:2864
    ds_read_b64_tr_b16 v[44:45], v151 offset:80
    ds_read_b64_tr_b16 v[46:47], v153 offset:2880
    s_waitcnt lgkmcnt(0)
    v_mfma_f32_16x16x32_bf16 v[112:115], v[16:19], v[164:167], v[72:75]
    v_mfma_f32_16x16x32_bf16 v[116:119], v[20:23], v[164:167], v[72:75]
    v_mfma_f32_16x16x32_bf16 v[120:123], v[24:27], v[164:167], v[76:79]
    v_mfma_f32_16x16x32_bf16 v[124:127], v[28:31], v[164:167], v[76:79]
    v_mfma_f32_16x16x32_bf16 v[128:131], v[32:35], v[164:167], v[80:83]
    v_mfma_f32_16x16x32_bf16 v[132:135], v[36:39], v[164:167], v[80:83]
    v_mfma_f32_16x16x32_bf16 v[104:107], v[8:11], v[164:167], v[84:87]
    v_mfma_f32_16x16x32_bf16 v[108:111], v[12:15], v[164:167], v[84:87]
    s_mov_b64 exec, s[44:45]
    ds_read_b128 v[144:147], v154 offset:12288
    s_mov_b64 exec, -1
    v_cndmask_b32 v112, v116, v112, s[46:47]
    v_cndmask_b32 v113, v117, v113, s[46:47]
    v_cndmask_b32 v114, v118, v114, s[48:49]
    v_cndmask_b32 v115, v119, v115, s[48:49]
    v_cndmask_b32 v120, v124, v120, s[46:47]
    v_cndmask_b32 v121, v125, v121, s[46:47]
    v_cndmask_b32 v122, v126, v122, s[48:49]
    v_cndmask_b32 v123, v127, v123, s[48:49]
    v_cndmask_b32 v128, v132, v128, s[46:47]
    v_cndmask_b32 v129, v133, v129, s[46:47]
    v_cndmask_b32 v130, v134, v130, s[48:49]
    v_cndmask_b32 v131, v135, v131, s[48:49]
    v_cndmask_b32 v104, v108, v104, s[46:47]
    v_cndmask_b32 v105, v109, v105, s[46:47]
    v_cndmask_b32 v106, v110, v106, s[48:49]
    v_cndmask_b32 v107, v111, v107, s[48:49]
    v_max_f32 v161, v104, v105
    v_max3_f32 v161, v161, v106, v107
    v_max3_f32 v161, v161, v112, v113
    v_max3_f32 v161, v161, v114, v115
    v_max3_f32 v161, v161, v120, v121
    v_max3_f32 v161, v161, v122, v123
    v_max3_f32 v161, v161, v128, v129
    v_max3_f32 v161, v161, v130, v131
    ds_bpermute_b32 v162, v163, v161
    v_xor_b32 v163, 192, v163
    s_waitcnt lgkmcnt(0)
    v_max_f32 v161, v161, v162
    ds_bpermute_b32 v162, v163, v161
    v_xor_b32 v163, 192, v163
    s_waitcnt lgkmcnt(0)
    v_max_f32 v161, v161, v162
    v_sub_f32 v104, v104, v161
    v_sub_f32 v105, v105, v161
    v_sub_f32 v106, v106, v161
    v_sub_f32 v107, v107, v161
    v_sub_f32 v112, v112, v161
    v_sub_f32 v113, v113, v161
    v_sub_f32 v114, v114, v161
    v_sub_f32 v115, v115, v161
    v_sub_f32 v120, v120, v161
    v_sub_f32 v121, v121, v161
    v_sub_f32 v122, v122, v161
    v_sub_f32 v123, v123, v161
    v_sub_f32 v128, v128, v161
    v_sub_f32 v129, v129, v161
    v_sub_f32 v130, v130, v161
    v_sub_f32 v131, v131, v161
    v_exp_f32 v112, v112
    v_exp_f32 v113, v113
    v_exp_f32 v114, v114
    v_exp_f32 v115, v115
    s_mov_b64 exec, s[46:47]
    v_cvt_pk_bf16_f32 v92, v112, v113
    s_mov_b64 exec, s[50:51]
    v_cvt_pk_bf16_f32 v94, v112, v113
    s_mov_b64 exec, -1
    s_mov_b64 exec, s[48:49]
    v_cvt_pk_bf16_f32 v93, v114, v115
    s_mov_b64 exec, s[8:9]
    v_cvt_pk_bf16_f32 v95, v114, v115
    s_mov_b64 exec, -1
    s_nop 0
    v_mfma_f32_16x16x32_bf16 v[136:139], v[48:51], v[92:95], 0
    v_mfma_f32_16x16x32_bf16 v[140:143], v[52:55], v[92:95], 0
    v_exp_f32 v120, v120
    v_exp_f32 v121, v121
    v_exp_f32 v122, v122
    v_exp_f32 v123, v123
    s_mov_b64 exec, s[46:47]
    v_cvt_pk_bf16_f32 v96, v120, v121
    s_mov_b64 exec, s[50:51]
    v_cvt_pk_bf16_f32 v98, v120, v121
    s_mov_b64 exec, -1
    s_mov_b64 exec, s[48:49]
    v_cvt_pk_bf16_f32 v97, v122, v123
    s_mov_b64 exec, s[8:9]
    v_cvt_pk_bf16_f32 v99, v122, v123
    s_mov_b64 exec, -1
    s_nop 0
    v_mfma_f32_16x16x32_bf16 v[136:139], v[56:59], v[96:99], v[136:139]
    v_mfma_f32_16x16x32_bf16 v[140:143], v[60:63], v[96:99], v[140:143]
    v_exp_f32 v128, v128
    v_exp_f32 v129, v129
    v_exp_f32 v130, v130
    v_exp_f32 v131, v131
    s_mov_b64 exec, s[46:47]
    v_cvt_pk_bf16_f32 v100, v128, v129
    s_mov_b64 exec, s[50:51]
    v_cvt_pk_bf16_f32 v102, v128, v129
    s_mov_b64 exec, -1
    s_mov_b64 exec, s[48:49]
    v_cvt_pk_bf16_f32 v101, v130, v131
    s_mov_b64 exec, s[8:9]
    v_cvt_pk_bf16_f32 v103, v130, v131
    s_mov_b64 exec, -1
    s_nop 0
    v_mfma_f32_16x16x32_bf16 v[136:139], v[64:67], v[100:103], v[136:139]
    v_mfma_f32_16x16x32_bf16 v[140:143], v[68:71], v[100:103], v[140:143]
    v_exp_f32 v104, v104
    v_exp_f32 v105, v105
    v_exp_f32 v106, v106
    v_exp_f32 v107, v107
    s_mov_b64 exec, s[46:47]
    v_cvt_pk_bf16_f32 v88, v104, v105
    s_mov_b64 exec, s[50:51]
    v_cvt_pk_bf16_f32 v90, v104, v105
    s_mov_b64 exec, -1
    s_mov_b64 exec, s[48:49]
    v_cvt_pk_bf16_f32 v89, v106, v107
    s_mov_b64 exec, s[8:9]
    v_cvt_pk_bf16_f32 v91, v106, v107
    s_mov_b64 exec, -1
    s_nop 0
    v_mfma_f32_16x16x32_bf16 v[136:139], v[40:43], v[88:91], v[136:139]
    v_mfma_f32_16x16x32_bf16 v[140:143], v[44:47], v[88:91], v[140:143]
    s_nop 7
    v_permlane32_swap_b32 v140, v142
    v_permlane32_swap_b32 v141, v143
    v_rcp_f32 v160, v142
    s_nop 0
    v_max3_f32 v159, v159, v142, v160
    v_mul_f32 v136, v136, v160
    v_mul_f32 v137, v137, v160
    v_mul_f32 v138, v138, v160
    v_mul_f32 v139, v139, v160
    v_cvt_pk_bf16_f32 v136, v136, v137
    v_cvt_pk_bf16_f32 v137, v138, v139
    v_mul_f32 v140, v140, v160
    v_mul_f32 v141, v141, v160
    ds_write_b64 v155, v[136:137] offset:12288
    v_cvt_pk_bf16_f32 v140, v140, v141
    ds_write_b32 v156, v140 offset:12800
    s_waitcnt lgkmcnt(0)
    s_barrier
    ds_read_b128 v[16:19], v148 offset:16000
    ds_read_b128 v[20:23], v149 offset:18800
    ds_read_b64_tr_b16 v[48:49], v150 offset:16064
    ds_read_b64_tr_b16 v[50:51], v152 offset:18864
    ds_read_b64_tr_b16 v[52:53], v151 offset:16080
    ds_read_b64_tr_b16 v[54:55], v153 offset:18880
    s_waitcnt lgkmcnt(0)
    v_mfma_f32_16x16x32_bf16 v[120:123], v[24:27], v[144:147], v[72:75]
    v_mfma_f32_16x16x32_bf16 v[124:127], v[28:31], v[144:147], v[72:75]
    v_mfma_f32_16x16x32_bf16 v[128:131], v[32:35], v[144:147], v[76:79]
    v_mfma_f32_16x16x32_bf16 v[132:135], v[36:39], v[144:147], v[76:79]
    v_mfma_f32_16x16x32_bf16 v[104:107], v[8:11], v[144:147], v[80:83]
    v_mfma_f32_16x16x32_bf16 v[108:111], v[12:15], v[144:147], v[80:83]
    v_mfma_f32_16x16x32_bf16 v[112:115], v[16:19], v[144:147], v[84:87]
    v_mfma_f32_16x16x32_bf16 v[116:119], v[20:23], v[144:147], v[84:87]
    s_mov_b64 exec, s[44:45]
    ds_read_b128 v[164:167], v154 offset:0
    s_mov_b64 exec, -1
    v_cndmask_b32 v120, v124, v120, s[46:47]
    v_cndmask_b32 v121, v125, v121, s[46:47]
    v_cndmask_b32 v122, v126, v122, s[48:49]
    v_cndmask_b32 v123, v127, v123, s[48:49]
    v_cndmask_b32 v128, v132, v128, s[46:47]
    v_cndmask_b32 v129, v133, v129, s[46:47]
    v_cndmask_b32 v130, v134, v130, s[48:49]
    v_cndmask_b32 v131, v135, v131, s[48:49]
    v_cndmask_b32 v104, v108, v104, s[46:47]
    v_cndmask_b32 v105, v109, v105, s[46:47]
    v_cndmask_b32 v106, v110, v106, s[48:49]
    v_cndmask_b32 v107, v111, v107, s[48:49]
    v_cndmask_b32 v112, v116, v112, s[46:47]
    v_cndmask_b32 v113, v117, v113, s[46:47]
    v_cndmask_b32 v114, v118, v114, s[48:49]
    v_cndmask_b32 v115, v119, v115, s[48:49]
    v_max_f32 v161, v104, v105
    v_max3_f32 v161, v161, v106, v107
    v_max3_f32 v161, v161, v112, v113
    v_max3_f32 v161, v161, v114, v115
    v_max3_f32 v161, v161, v120, v121
    v_max3_f32 v161, v161, v122, v123
    v_max3_f32 v161, v161, v128, v129
    v_max3_f32 v161, v161, v130, v131
    ds_bpermute_b32 v162, v163, v161
    v_xor_b32 v163, 192, v163
    s_waitcnt lgkmcnt(0)
    v_max_f32 v161, v161, v162
    ds_bpermute_b32 v162, v163, v161
    v_xor_b32 v163, 192, v163
    s_waitcnt lgkmcnt(0)
    v_max_f32 v161, v161, v162
    v_sub_f32 v104, v104, v161
    v_sub_f32 v105, v105, v161
    v_sub_f32 v106, v106, v161
    v_sub_f32 v107, v107, v161
    v_sub_f32 v112, v112, v161
    v_sub_f32 v113, v113, v161
    v_sub_f32 v114, v114, v161
    v_sub_f32 v115, v115, v161
    v_sub_f32 v120, v120, v161
    v_sub_f32 v121, v121, v161
    v_sub_f32 v122, v122, v161
    v_sub_f32 v123, v123, v161
    v_sub_f32 v128, v128, v161
    v_sub_f32 v129, v129, v161
    v_sub_f32 v130, v130, v161
    v_sub_f32 v131, v131, v161
    v_exp_f32 v120, v120
    v_exp_f32 v121, v121
    v_exp_f32 v122, v122
    v_exp_f32 v123, v123
    s_mov_b64 exec, s[46:47]
    v_cvt_pk_bf16_f32 v96, v120, v121
    s_mov_b64 exec, s[50:51]
    v_cvt_pk_bf16_f32 v98, v120, v121
    s_mov_b64 exec, -1
    s_mov_b64 exec, s[48:49]
    v_cvt_pk_bf16_f32 v97, v122, v123
    s_mov_b64 exec, s[8:9]
    v_cvt_pk_bf16_f32 v99, v122, v123
    s_mov_b64 exec, -1
    s_nop 0
    v_mfma_f32_16x16x32_bf16 v[136:139], v[56:59], v[96:99], 0
    v_mfma_f32_16x16x32_bf16 v[140:143], v[60:63], v[96:99], 0
    v_exp_f32 v128, v128
    v_exp_f32 v129, v129
    v_exp_f32 v130, v130
    v_exp_f32 v131, v131
    s_mov_b64 exec, s[46:47]
    v_cvt_pk_bf16_f32 v100, v128, v129
    s_mov_b64 exec, s[50:51]
    v_cvt_pk_bf16_f32 v102, v128, v129
    s_mov_b64 exec, -1
    s_mov_b64 exec, s[48:49]
    v_cvt_pk_bf16_f32 v101, v130, v131
    s_mov_b64 exec, s[8:9]
    v_cvt_pk_bf16_f32 v103, v130, v131
    s_mov_b64 exec, -1
    s_nop 0
    v_mfma_f32_16x16x32_bf16 v[136:139], v[64:67], v[100:103], v[136:139]
    v_mfma_f32_16x16x32_bf16 v[140:143], v[68:71], v[100:103], v[140:143]
    v_exp_f32 v104, v104
    v_exp_f32 v105, v105
    v_exp_f32 v106, v106
    v_exp_f32 v107, v107
    s_mov_b64 exec, s[46:47]
    v_cvt_pk_bf16_f32 v88, v104, v105
    s_mov_b64 exec, s[50:51]
    v_cvt_pk_bf16_f32 v90, v104, v105
    s_mov_b64 exec, -1
    s_mov_b64 exec, s[48:49]
    v_cvt_pk_bf16_f32 v89, v106, v107
    s_mov_b64 exec, s[8:9]
    v_cvt_pk_bf16_f32 v91, v106, v107
    s_mov_b64 exec, -1
    s_nop 0
    v_mfma_f32_16x16x32_bf16 v[136:139], v[40:43], v[88:91], v[136:139]
    v_mfma_f32_16x16x32_bf16 v[140:143], v[44:47], v[88:91], v[140:143]
    v_exp_f32 v112, v112
    v_exp_f32 v113, v113
    v_exp_f32 v114, v114
    v_exp_f32 v115, v115
    s_mov_b64 exec, s[46:47]
    v_cvt_pk_bf16_f32 v92, v112, v113
    s_mov_b64 exec, s[50:51]
    v_cvt_pk_bf16_f32 v94, v112, v113
    s_mov_b64 exec, -1
    s_mov_b64 exec, s[48:49]
    v_cvt_pk_bf16_f32 v93, v114, v115
    s_mov_b64 exec, s[8:9]
    v_cvt_pk_bf16_f32 v95, v114, v115
    s_mov_b64 exec, -1
    s_nop 0
    v_mfma_f32_16x16x32_bf16 v[136:139], v[48:51], v[92:95], v[136:139]
    v_mfma_f32_16x16x32_bf16 v[140:143], v[52:55], v[92:95], v[140:143]
    s_nop 7
    v_permlane32_swap_b32 v140, v142
    v_permlane32_swap_b32 v141, v143
    v_rcp_f32 v160, v142
    s_nop 0
    v_max3_f32 v159, v159, v142, v160
    v_mul_f32 v136, v136, v160
    v_mul_f32 v137, v137, v160
    v_mul_f32 v138, v138, v160
    v_mul_f32 v139, v139, v160
    v_cvt_pk_bf16_f32 v136, v136, v137
    v_cvt_pk_bf16_f32 v137, v138, v139
    v_mul_f32 v140, v140, v160
    v_mul_f32 v141, v141, v160
    ds_write_b64 v155, v[136:137] offset:0
    v_cvt_pk_bf16_f32 v140, v140, v141
    ds_write_b32 v156, v140 offset:512
    s_waitcnt lgkmcnt(0)
    s_barrier
    ds_read_b128 v[24:27], v148 offset:32000
    ds_read_b128 v[28:31], v149 offset:34800
    ds_read_b64_tr_b16 v[56:57], v150 offset:32064
    ds_read_b64_tr_b16 v[58:59], v152 offset:34864
    ds_read_b64_tr_b16 v[60:61], v151 offset:32080
    ds_read_b64_tr_b16 v[62:63], v153 offset:34880
    s_cmp_eq_u32 s38, 0
    s_cbranch_scc1 L_e5s
    ds_read2_b32 v[72:73], v1 offset0:34 offset1:51
    ds_read2_b32 v[74:75], v2 offset0:35 offset1:52
    v_mov_b32 v85, 0xff800000
    v_mov_b32 v87, 0xff800000
L_e5s:
    s_waitcnt lgkmcnt(0)
    v_mfma_f32_16x16x32_bf16 v[128:131], v[32:35], v[164:167], v[72:75]
    v_mfma_f32_16x16x32_bf16 v[132:135], v[36:39], v[164:167], v[72:75]
    v_mfma_f32_16x16x32_bf16 v[104:107], v[8:11], v[164:167], v[76:79]
    v_mfma_f32_16x16x32_bf16 v[108:111], v[12:15], v[164:167], v[76:79]
    v_mfma_f32_16x16x32_bf16 v[112:115], v[16:19], v[164:167], v[80:83]
    v_mfma_f32_16x16x32_bf16 v[116:119], v[20:23], v[164:167], v[80:83]
    v_mfma_f32_16x16x32_bf16 v[120:123], v[24:27], v[164:167], v[84:87]
    v_mfma_f32_16x16x32_bf16 v[124:127], v[28:31], v[164:167], v[84:87]
    s_mov_b64 exec, s[44:45]
    ds_read_b128 v[144:147], v154 offset:6144
    s_mov_b64 exec, -1
    v_cndmask_b32 v128, v132, v128, s[46:47]
    v_cndmask_b32 v129, v133, v129, s[46:47]
    v_cndmask_b32 v130, v134, v130, s[48:49]
    v_cndmask_b32 v131, v135, v131, s[48:49]
    v_cndmask_b32 v104, v108, v104, s[46:47]
    v_cndmask_b32 v105, v109, v105, s[46:47]
    v_cndmask_b32 v106, v110, v106, s[48:49]
    v_cndmask_b32 v107, v111, v107, s[48:49]
    v_cndmask_b32 v112, v116, v112, s[46:47]
    v_cndmask_b32 v113, v117, v113, s[46:47]
    v_cndmask_b32 v114, v118, v114, s[48:49]
    v_cndmask_b32 v115, v119, v115, s[48:49]
    v_cndmask_b32 v120, v124, v120, s[46:47]
    v_cndmask_b32 v121, v125, v121, s[46:47]
    v_cndmask_b32 v122, v126, v122, s[48:49]
    v_cndmask_b32 v123, v127, v123, s[48:49]
    v_max_f32 v161, v104, v105
    v_max3_f32 v161, v161, v106, v107
    v_max3_f32 v161, v161, v112, v113
    v_max3_f32 v161, v161, v114, v115
    v_max3_f32 v161, v161, v120, v121
    v_max3_f32 v161, v161, v122, v123
    v_max3_f32 v161, v161, v128, v129
    v_max3_f32 v161, v161, v130, v131
    ds_bpermute_b32 v162, v163, v161
    v_xor_b32 v163, 192, v163
    s_waitcnt lgkmcnt(0)
    v_max_f32 v161, v161, v162
    ds_bpermute_b32 v162, v163, v161
    v_xor_b32 v163, 192, v163
    s_waitcnt lgkmcnt(0)
    v_max_f32 v161, v161, v162
    v_sub_f32 v104, v104, v161
    v_sub_f32 v105, v105, v161
    v_sub_f32 v106, v106, v161
    v_sub_f32 v107, v107, v161
    v_sub_f32 v112, v112, v161
    v_sub_f32 v113, v113, v161
    v_sub_f32 v114, v114, v161
    v_sub_f32 v115, v115, v161
    v_sub_f32 v120, v120, v161
    v_sub_f32 v121, v121, v161
    v_sub_f32 v122, v122, v161
    v_sub_f32 v123, v123, v161
    v_sub_f32 v128, v128, v161
    v_sub_f32 v129, v129, v161
    v_sub_f32 v130, v130, v161
    v_sub_f32 v131, v131, v161
    v_exp_f32 v128, v128
    v_exp_f32 v129, v129
    v_exp_f32 v130, v130
    v_exp_f32 v131, v131
    s_mov_b64 exec, s[46:47]
    v_cvt_pk_bf16_f32 v100, v128, v129
    s_mov_b64 exec, s[50:51]
    v_cvt_pk_bf16_f32 v102, v128, v129
    s_mov_b64 exec, -1
    s_mov_b64 exec, s[48:49]
    v_cvt_pk_bf16_f32 v101, v130, v131
    s_mov_b64 exec, s[8:9]
    v_cvt_pk_bf16_f32 v103, v130, v131
    s_mov_b64 exec, -1
    s_nop 0
    v_mfma_f32_16x16x32_bf16 v[136:139], v[64:67], v[100:103], 0
    v_mfma_f32_16x16x32_bf16 v[140:143], v[68:71], v[100:103], 0
    v_exp_f32 v104, v104
    v_exp_f32 v105, v105
    v_exp_f32 v106, v106
    v_exp_f32 v107, v107
    s_mov_b64 exec, s[46:47]
    v_cvt_pk_bf16_f32 v88, v104, v105
    s_mov_b64 exec, s[50:51]
    v_cvt_pk_bf16_f32 v90, v104, v105
    s_mov_b64 exec, -1
    s_mov_b64 exec, s[48:49]
    v_cvt_pk_bf16_f32 v89, v106, v107
    s_mov_b64 exec, s[8:9]
    v_cvt_pk_bf16_f32 v91, v106, v107
    s_mov_b64 exec, -1
    s_nop 0
    v_mfma_f32_16x16x32_bf16 v[136:139], v[40:43], v[88:91], v[136:139]
    v_mfma_f32_16x16x32_bf16 v[140:143], v[44:47], v[88:91], v[140:143]
    v_exp_f32 v112, v112
    v_exp_f32 v113, v113
    v_exp_f32 v114, v114
    v_exp_f32 v115, v115
    s_mov_b64 exec, s[46:47]
    v_cvt_pk_bf16_f32 v92, v112, v113
    s_mov_b64 exec, s[50:51]
    v_cvt_pk_bf16_f32 v94, v112, v113
    s_mov_b64 exec, -1
    s_mov_b64 exec, s[48:49]
    v_cvt_pk_bf16_f32 v93, v114, v115
    s_mov_b64 exec, s[8:9]
    v_cvt_pk_bf16_f32 v95, v114, v115
    s_mov_b64 exec, -1
    s_nop 0
    v_mfma_f32_16x16x32_bf16 v[136:139], v[48:51], v[92:95], v[136:139]
    v_mfma_f32_16x16x32_bf16 v[140:143], v[52:55], v[92:95], v[140:143]
    v_exp_f32 v120, v120
    v_exp_f32 v121, v121
    v_exp_f32 v122, v122
    v_exp_f32 v123, v123
    s_mov_b64 exec, s[46:47]
    v_cvt_pk_bf16_f32 v96, v120, v121
    s_mov_b64 exec, s[50:51]
    v_cvt_pk_bf16_f32 v98, v120, v121
    s_mov_b64 exec, -1
    s_mov_b64 exec, s[48:49]
    v_cvt_pk_bf16_f32 v97, v122, v123
    s_mov_b64 exec, s[8:9]
    v_cvt_pk_bf16_f32 v99, v122, v123
    s_mov_b64 exec, -1
    s_nop 0
    v_mfma_f32_16x16x32_bf16 v[136:139], v[56:59], v[96:99], v[136:139]
    v_mfma_f32_16x16x32_bf16 v[140:143], v[60:63], v[96:99], v[140:143]
    s_nop 7
    v_permlane32_swap_b32 v140, v142
    v_permlane32_swap_b32 v141, v143
    v_rcp_f32 v160, v142
    s_nop 0
    v_max3_f32 v159, v159, v142, v160
    v_mul_f32 v136, v136, v160
    v_mul_f32 v137, v137, v160
    v_mul_f32 v138, v138, v160
    v_mul_f32 v139, v139, v160
    v_cvt_pk_bf16_f32 v136, v136, v137
    v_cvt_pk_bf16_f32 v137, v138, v139
    v_mul_f32 v140, v140, v160
    v_mul_f32 v141, v141, v160
    ds_write_b64 v155, v[136:137] offset:6144
    v_cvt_pk_bf16_f32 v140, v140, v141
    ds_write_b32 v156, v140 offset:6656
    s_waitcnt lgkmcnt(0)
    s_barrier
    s_cmp_lg_u32 s38, 0
    s_cbranch_scc1 L_s9s
    ds_read_b128 v[32:35], v148 offset:48000
    ds_read_b128 v[36:39], v149 offset:50800
    ds_read_b64_tr_b16 v[64:65], v150 offset:48064
    ds_read_b64_tr_b16 v[66:67], v152 offset:50864
    ds_read_b64_tr_b16 v[68:69], v151 offset:48080
    ds_read_b64_tr_b16 v[70:71], v153 offset:50880
L_s9s:
    s_cmp_eq_u32 s38, 0
    s_cbranch_scc1 L_e6s
    ds_read2_b32 v[84:85], v1 offset0:0 offset1:17
    ds_read2_b32 v[86:87], v2 offset0:1 offset1:18
    v_mov_b32 v81, 0xff800000
    v_mov_b32 v83, 0xff800000
L_e6s:
    s_waitcnt lgkmcnt(0)
    v_mfma_f32_16x16x32_bf16 v[104:107], v[8:11], v[144:147], v[72:75]
    v_mfma_f32_16x16x32_bf16 v[108:111], v[12:15], v[144:147], v[72:75]
    v_mfma_f32_16x16x32_bf16 v[112:115], v[16:19], v[144:147], v[76:79]
    v_mfma_f32_16x16x32_bf16 v[116:119], v[20:23], v[144:147], v[76:79]
    v_mfma_f32_16x16x32_bf16 v[120:123], v[24:27], v[144:147], v[80:83]
    v_mfma_f32_16x16x32_bf16 v[124:127], v[28:31], v[144:147], v[80:83]
    v_mfma_f32_16x16x32_bf16 v[128:131], v[32:35], v[144:147], v[84:87]
    v_mfma_f32_16x16x32_bf16 v[132:135], v[36:39], v[144:147], v[84:87]
    s_nop 1
    v_cndmask_b32 v104, v108, v104, s[46:47]
    v_cndmask_b32 v105, v109, v105, s[46:47]
    v_cndmask_b32 v106, v110, v106, s[48:49]
    v_cndmask_b32 v107, v111, v107, s[48:49]
    v_cndmask_b32 v112, v116, v112, s[46:47]
    v_cndmask_b32 v113, v117, v113, s[46:47]
    v_cndmask_b32 v114, v118, v114, s[48:49]
    v_cndmask_b32 v115, v119, v115, s[48:49]
    v_cndmask_b32 v120, v124, v120, s[46:47]
    v_cndmask_b32 v121, v125, v121, s[46:47]
    v_cndmask_b32 v122, v126, v122, s[48:49]
    v_cndmask_b32 v123, v127, v123, s[48:49]
    v_cndmask_b32 v128, v132, v128, s[46:47]
    v_cndmask_b32 v129, v133, v129, s[46:47]
    v_cndmask_b32 v130, v134, v130, s[48:49]
    v_cndmask_b32 v131, v135, v131, s[48:49]
    v_max_f32 v161, v104, v105
    v_max3_f32 v161, v161, v106, v107
    v_max3_f32 v161, v161, v112, v113
    v_max3_f32 v161, v161, v114, v115
    v_max3_f32 v161, v161, v120, v121
    v_max3_f32 v161, v161, v122, v123
    v_max3_f32 v161, v161, v128, v129
    v_max3_f32 v161, v161, v130, v131
    ds_bpermute_b32 v162, v163, v161
    v_xor_b32 v163, 192, v163
    s_waitcnt lgkmcnt(0)
    v_max_f32 v161, v161, v162
    ds_bpermute_b32 v162, v163, v161
    v_xor_b32 v163, 192, v163
    s_waitcnt lgkmcnt(0)
    v_max_f32 v161, v161, v162
    v_sub_f32 v104, v104, v161
    v_sub_f32 v105, v105, v161
    v_sub_f32 v106, v106, v161
    v_sub_f32 v107, v107, v161
    v_sub_f32 v112, v112, v161
    v_sub_f32 v113, v113, v161
    v_sub_f32 v114, v114, v161
    v_sub_f32 v115, v115, v161
    v_sub_f32 v120, v120, v161
    v_sub_f32 v121, v121, v161
    v_sub_f32 v122, v122, v161
    v_sub_f32 v123, v123, v161
    v_sub_f32 v128, v128, v161
    v_sub_f32 v129, v129, v161
    v_sub_f32 v130, v130, v161
    v_sub_f32 v131, v131, v161
    v_exp_f32 v104, v104
    v_exp_f32 v105, v105
    v_exp_f32 v106, v106
    v_exp_f32 v107, v107
    s_mov_b64 exec, s[46:47]
    v_cvt_pk_bf16_f32 v88, v104, v105
    s_mov_b64 exec, s[50:51]
    v_cvt_pk_bf16_f32 v90, v104, v105
    s_mov_b64 exec, -1
    s_mov_b64 exec, s[48:49]
    v_cvt_pk_bf16_f32 v89, v106, v107
    s_mov_b64 exec, s[8:9]
    v_cvt_pk_bf16_f32 v91, v106, v107
    s_mov_b64 exec, -1
    s_nop 0
    v_mfma_f32_16x16x32_bf16 v[136:139], v[40:43], v[88:91], 0
    v_mfma_f32_16x16x32_bf16 v[140:143], v[44:47], v[88:91], 0
    v_exp_f32 v112, v112
    v_exp_f32 v113, v113
    v_exp_f32 v114, v114
    v_exp_f32 v115, v115
    s_mov_b64 exec, s[46:47]
    v_cvt_pk_bf16_f32 v92, v112, v113
    s_mov_b64 exec, s[50:51]
    v_cvt_pk_bf16_f32 v94, v112, v113
    s_mov_b64 exec, -1
    s_mov_b64 exec, s[48:49]
    v_cvt_pk_bf16_f32 v93, v114, v115
    s_mov_b64 exec, s[8:9]
    v_cvt_pk_bf16_f32 v95, v114, v115
    s_mov_b64 exec, -1
    s_nop 0
    v_mfma_f32_16x16x32_bf16 v[136:139], v[48:51], v[92:95], v[136:139]
    v_mfma_f32_16x16x32_bf16 v[140:143], v[52:55], v[92:95], v[140:143]
    v_exp_f32 v120, v120
    v_exp_f32 v121, v121
    v_exp_f32 v122, v122
    v_exp_f32 v123, v123
    s_mov_b64 exec, s[46:47]
    v_cvt_pk_bf16_f32 v96, v120, v121
    s_mov_b64 exec, s[50:51]
    v_cvt_pk_bf16_f32 v98, v120, v121
    s_mov_b64 exec, -1
    s_mov_b64 exec, s[48:49]
    v_cvt_pk_bf16_f32 v97, v122, v123
    s_mov_b64 exec, s[8:9]
    v_cvt_pk_bf16_f32 v99, v122, v123
    s_mov_b64 exec, -1
    s_nop 0
    v_mfma_f32_16x16x32_bf16 v[136:139], v[56:59], v[96:99], v[136:139]
    v_mfma_f32_16x16x32_bf16 v[140:143], v[60:63], v[96:99], v[140:143]
    v_exp_f32 v128, v128
    v_exp_f32 v129, v129
    v_exp_f32 v130, v130
    v_exp_f32 v131, v131
    s_mov_b64 exec, s[46:47]
    v_cvt_pk_bf16_f32 v100, v128, v129
    s_mov_b64 exec, s[50:51]
    v_cvt_pk_bf16_f32 v102, v128, v129
    s_mov_b64 exec, -1
    s_mov_b64 exec, s[48:49]
    v_cvt_pk_bf16_f32 v101, v130, v131
    s_mov_b64 exec, s[8:9]
    v_cvt_pk_bf16_f32 v103, v130, v131
    s_mov_b64 exec, -1
    s_nop 0
    v_mfma_f32_16x16x32_bf16 v[136:139], v[64:67], v[100:103], v[136:139]
    v_mfma_f32_16x16x32_bf16 v[140:143], v[68:71], v[100:103], v[140:143]
    s_nop 7
    v_permlane32_swap_b32 v140, v142
    v_permlane32_swap_b32 v141, v143
    v_rcp_f32 v160, v142
    s_nop 0
    v_max3_f32 v159, v159, v142, v160
    v_mul_f32 v136, v136, v160
    v_mul_f32 v137, v137, v160
    v_mul_f32 v138, v138, v160
    v_mul_f32 v139, v139, v160
    v_cvt_pk_bf16_f32 v136, v136, v137
    v_cvt_pk_bf16_f32 v137, v138, v139
    v_mul_f32 v140, v140, v160
    v_mul_f32 v141, v141, v160
    ds_write_b64 v155, v[136:137] offset:12288
    v_cvt_pk_bf16_f32 v140, v140, v141
    ds_write_b32 v156, v140 offset:12800
    s_waitcnt lgkmcnt(0)
    s_barrier
    s_branch L_fin
L_last:
.if L_last - standalone__neighborhood_dinat__vision_kernel < 29184
.error "prefetch range"
.endif
.section .rodata,"a"
.p2align 6
.amdhsa_kernel standalone__neighborhood_dinat__vision_kernel
  .amdhsa_next_free_vgpr 168
  .amdhsa_next_free_sgpr 102
  .amdhsa_accum_offset 168
  .amdhsa_group_segment_fixed_size 0
  .amdhsa_kernarg_size 56
  .amdhsa_user_sgpr_count 2
  .amdhsa_user_sgpr_kernarg_segment_ptr 1
  .amdhsa_system_sgpr_workgroup_id_x 1
.end_amdhsa_kernel
```
